```python
import torch

def _softmax(x, axis=-1):
    return torch.softmax(x, dim=axis)

def _gelu(x):
    return torch.nn.functional.gelu(x, approximate='tanh')

def _silu(x):
    return torch.nn.functional.silu(x)

def _sigmoid(x):
    return torch.sigmoid(x)

def _layernorm(x, axis=-1, eps=1e-05):
    m = x.mean(dim=axis, keepdim=True)
    v = x.var(dim=axis, keepdim=True, unbiased=False)
    return (x - m) / torch.sqrt(v + eps)

def _scatter_add(tgt, idx, src, axis=0):
    return tgt.clone().index_add_(axis, idx, src)

def _segment_sum(src, seg, n):
    out = torch.zeros((n,) + src.shape[1:], dtype=src.dtype)
    return out.index_add_(0, seg, src)

def _pad(x, pw):
    flat = tuple((v for pair in reversed(pw) for v in pair))
    return torch.nn.functional.pad(x, flat)
kernel_name = 'standalone__detection_seg_detr_decoder__vision'

def setup_inputs():

    _w = lambda a: (lambda t: t.to(torch.bfloat16) if t.is_floating_point() else t)(torch.as_tensor(a))
    H = W = 384 // 2 * 2
    C = 384
    Nq = 32
    return {'q': _w((lambda *s: torch.randn(*s, dtype=torch.bfloat16) * 0.05)(1, Nq, C)), 'feat_hi': _w((lambda *s: torch.randn(*s, dtype=torch.bfloat16) * 0.1)(1, H, W, C)), 'feat_lo': _w((lambda *s: torch.randn(*s, dtype=torch.bfloat16) * 0.1)(1, H // 2, W // 2, C)), 'lat_hi': _w((lambda *s: torch.randn(*s, dtype=torch.bfloat16) * 0.1)(C, C)), 'lat_lo': _w((lambda *s: torch.randn(*s, dtype=torch.bfloat16) * 0.1)(C, C)), 'wq': _w((lambda *s: torch.randn(*s, dtype=torch.bfloat16) * 0.1)(C, C)), 'wkv': _w((lambda *s: torch.randn(*s, dtype=torch.bfloat16) * 0.1)(C, 2 * C)), 'wo': _w((lambda *s: torch.randn(*s, dtype=torch.bfloat16) * 0.05)(C, C)), 'w1': _w((lambda *s: torch.randn(*s, dtype=torch.bfloat16) * 0.05)(C, 4 * C)), 'w2': _w((lambda *s: torch.randn(*s, dtype=torch.bfloat16) * 0.05)(4 * C, C))}

def reference(q, feat_hi, feat_lo, lat_hi, lat_lo, wq, wkv, wo, w1, w2):
    B, Nq, C = q.shape
    _, H, W, _ = feat_hi.shape
    lo = feat_lo @ lat_lo
    up = (lambda x, n, axis: torch.repeat_interleave(x, n, dim=axis))((lambda x, n, axis: torch.repeat_interleave(x, n, dim=axis))(lo, 2, axis=1), 2, axis=2)
    fused = feat_hi @ lat_hi + up
    mem = fused.reshape(B, H * W, C)
    qn = _layernorm(q, axis=-1)
    Q = qn @ wq
    KV = mem @ wkv
    K, V = (KV[..., :C].clone(), KV[..., C:].clone())
    scale = C ** (-0.5)
    logits = torch.einsum('bqc,bkc->bqk', Q, K) * scale
    P = _softmax(logits, axis=-1)
    O = torch.einsum('bqk,bkc->bqc', P, V)
    h = q + O @ wo
    hn = _layernorm(h, axis=-1)
    return h + _gelu(hn @ w1) @ w2
```

```asm
; @launch grid=(256,1,1) block=(512,1,1) lds=159744
.amdgcn_target "amdgcn-amd-amdhsa--gfx950"
.text
.globl standalone__detection_seg_detr_decoder__vision_kernel
.p2align 8
.type standalone__detection_seg_detr_decoder__vision_kernel,@function
standalone__detection_seg_detr_decoder__vision_kernel:
    v_lshrrev_b32 v1, 6, v0
    v_and_b32 v0, 63, v0
    v_readfirstlane_b32 s7, v1
    s_load_dwordx2 s[8:9], s[0:1], 8
    s_load_dwordx2 s[98:99], s[0:1], 0
    s_load_dwordx2 s[12:13], s[0:1], 16
    s_load_dwordx2 s[16:17], s[0:1], 96
    s_load_dwordx2 s[20:21], s[0:1], 88
    s_cmpk_ge_u32 s2, 256
    s_cbranch_scc1 L_end
    s_mov_b32 s6, s2
    s_and_b32 s3, s7, 3
    s_lshr_b32 s2, s2, 2
    s_and_b32 s33, s6, 3
    s_cbranch_scc0 L_hent
    s_mul_i32 s35, s2, 3
    s_add_u32 s35, s35, s33
    s_sub_u32 s35, s35, 1
    s_bitcmp1_b32 15, s7
    s_cbranch_scc0 L_strm
    s_mov_b32 s31, s7
    s_mov_b32 s30, s35
    s_mov_b32 s32, 12
    s_branch L_tch
L_hent:
    s_cmp_ge_u32 s2, 60
    s_cbranch_scc1 L_spare
    s_cmp_lt_u32 s7, 4
    s_cbranch_scc1 L_hq
    s_cmp_gt_u32 s7, 5
    s_cbranch_scc1 L_extra
    s_mov_b32 s31, 2
    s_and_b32 s30, s2, 62
    s_add_u32 s30, s30, s3
    s_mov_b32 s32, 36
L_tch:
    s_lshl3_add_u32 s34, s31, 24
    s_load_dwordx2 s[96:97], s[0:1], s34
    s_mul_i32 s30, s30, s32
    v_add_u32 v2, s30, v0
    v_mul_u32_u24 v3, 0xaaab, v2
    v_lshrrev_b32 v3, 18, v3
    s_cmp_eq_u32 s31, 3
    s_cselect_b32 s30, 6, 0
    v_mad_u32_u24 v2, v3, s30, v2
    v_lshlrev_b32 v2, 7, v2
    s_bfm_b64 exec, s32, 0
    s_waitcnt lgkmcnt(0)
    global_load_dword v55, v2, s[96:97]
    s_mov_b64 exec, -1
    s_cmp_lg_u32 s33, 0
    s_cbranch_scc1 L_strm
    s_endpgm
L_hq:
    s_lshr_b32 s30, s2, 1
    s_lshl2_add_u32 s30, s30, s7
    s_min_u32 s30, s30, 0x5f
    s_bitcmp1_b32 s2, 0
    s_cselect_b32 s31, 0x60, 0
    s_add_u32 s30, s30, s31
    s_lshl_b32 s30, s30, 7
    v_mov_b32 v3, s30
    s_mov_b64 exec, 1
    s_waitcnt lgkmcnt(0)
    global_load_dword v255, v3, s[98:99]
    s_mov_b64 exec, -1
    s_cmp_lt_u32 s2, 48
    s_cbranch_scc1 L_tail
    s_branch L_pf
L_extra:
    s_lshl3_add_u32 s30, s2, s7
    s_bitcmp1_b32 s7, 0
    s_cselect_b32 s30, 0x1ff, s30
    s_cmpk_ge_u32 s30, 384
    s_cbranch_scc1 L_xend
    s_getreg_b32 s30, hwreg(HW_REG_XCC_ID, 0, 3)
    s_lshl_b32 s30, s30, 3
    s_lshl_b64 s[32:33], 1, s30
    s_and_b32 s30, s2, 1
    s_lshl_b32 s30, s30, 7
    v_mov_b32 v4, s30
    v_mov_b32 v2, s32
    v_mov_b32 v3, s33
    s_mov_b64 exec, 1
    s_waitcnt lgkmcnt(0)
    global_atomic_add_x2 v4, v[2:3], s[20:21] offset:8
L_xend:
    s_endpgm
L_strm:
    s_mul_hi_u32 s30, s35, 178956971
    s_mul_i32 s30, s30, 24
    s_add_u32 s26, s35, s30
    s_lshl_b32 s26, s26, 1
    s_and_b32 s4, s3, 1
    s_lshr_b32 s5, s3, 1
    s_mul_i32 s42, s5, 48
    s_add_u32 s42, s42, s4
    s_add_u32 s26, s26, s42
    s_mulk_i32 s26, 6144
    v_lshlrev_b32 v6, 4, v0
    s_mov_b32 s10, 113246208
    s_mov_b32 s11, 0x20000
    s_cmp_lt_u32 s7, 4
    s_cbranch_scc1 L_sw
    s_waitcnt lgkmcnt(0)
    buffer_load_dwordx4 v[40:43], v6, s[8:11], s26 offen offset:0 nt
    buffer_load_dwordx4 v[44:47], v6, s[8:11], s26 offen offset:1024 nt
    buffer_load_dwordx4 v[48:51], v6, s[8:11], s26 offen offset:2048 nt
    buffer_load_dwordx4 v[52:55], v6, s[8:11], s26 offen offset:3072 nt
    s_lshl2_add_u32 s27, s35, s3
    s_mulk_i32 s27, 1536
    v_add_u32 v7, 4096, v6
    s_mov_b32 s14, 28311552
    s_mov_b32 s15, 0x20000
    s_add_u32 s2, s35, 64
    buffer_load_dwordx4 v[56:59], v7, s[8:11], s26 offen offset:0 nt
    buffer_load_dwordx4 v[60:63], v7, s[8:11], s26 offen offset:1024 nt
    buffer_load_dwordx4 v[64:67], v6, s[12:15], s27 offen nt
    s_mov_b32 exec_hi, 0
    buffer_load_dwordx4 v[68:71], v6, s[12:15], s27 offen offset:1024 nt
    s_mov_b32 exec_hi, -1
    s_add_u32 s26, s26, 4718592
    s_add_u32 s27, s27, 1179648
    buffer_load_dwordx4 v[224:227], v6, s[8:11], s26 offen offset:0 nt
    buffer_load_dwordx4 v[228:231], v6, s[8:11], s26 offen offset:1024 nt
    s_lshl_b32 s41, s4, 1
    s_lshl_b32 s44, s5, 1
    s_mov_b32 s47, 0x78
    v_add_u32 v2, 0, v0
    v_mul_u32_u24 v3, 1366, v2
    v_lshrrev_b32 v3, 16, v3
    v_mul_u32_u24 v4, 48, v3
    v_sub_u32 v2, v2, v4
    v_lshlrev_b32 v8, 4, v4
    v_add_lshl_u32 v4, v3, s41, 2
    v_or_b32 v4, s44, v4
    v_xor_b32 v4, v4, v2
    v_lshl_add_u32 v16, v4, 4, v8
    v_and_or_b32 v5, v3, 1, s44
    v_lshlrev_b32 v5, 2, v5
    v_xor_b32 v2, v2, v5
    v_and_b32 v3, 2, v3
    v_lshrrev_b32 v3, v3, s47
    buffer_load_dwordx4 v[232:235], v6, s[8:11], s26 offen offset:2048 nt
    v_and_b32 v4, 3, v3
    v_xor_b32 v4, v4, v2
    v_lshl_add_u32 v10, v4, 4, v8
    v_bfe_u32 v4, v3, 4, 2
    v_xor_b32 v4, v4, v2
    v_lshl_add_u32 v4, v4, 4, v8
    v_add_u32 v13, 3072, v4
    v_add_u32 v2, 64, v0
    v_mul_u32_u24 v3, 1366, v2
    v_lshrrev_b32 v3, 16, v3
    v_mul_u32_u24 v4, 48, v3
    v_sub_u32 v2, v2, v4
    v_lshlrev_b32 v8, 4, v4
    v_add_lshl_u32 v4, v3, s41, 2
    v_or_b32 v4, s44, v4
    v_xor_b32 v4, v4, v2
    v_lshl_add_u32 v17, v4, 4, v8
    buffer_load_dwordx4 v[236:239], v6, s[8:11], s26 offen offset:3072 nt
    v_and_or_b32 v5, v3, 1, s44
    v_lshlrev_b32 v5, 2, v5
    v_xor_b32 v2, v2, v5
    v_and_b32 v3, 2, v3
    v_lshrrev_b32 v3, v3, s47
    v_and_b32 v4, 3, v3
    v_xor_b32 v4, v4, v2
    v_lshl_add_u32 v11, v4, 4, v8
    v_bfe_u32 v4, v3, 4, 2
    v_xor_b32 v4, v4, v2
    v_lshl_add_u32 v4, v4, 4, v8
    v_add_u32 v14, 3072, v4
    v_add_u32 v2, 128, v0
    v_mul_u32_u24 v3, 1366, v2
    v_lshrrev_b32 v3, 16, v3
    v_mul_u32_u24 v4, 48, v3
    v_sub_u32 v2, v2, v4
    v_lshlrev_b32 v8, 4, v4
    buffer_load_dwordx4 v[240:243], v7, s[8:11], s26 offen offset:0 nt
    v_and_or_b32 v5, v3, 1, s44
    v_lshlrev_b32 v5, 2, v5
    v_xor_b32 v2, v2, v5
    v_and_b32 v3, 2, v3
    v_lshrrev_b32 v3, v3, s47
    v_and_b32 v4, 3, v3
    v_xor_b32 v4, v4, v2
    v_lshl_add_u32 v12, v4, 4, v8
    v_bfe_u32 v4, v3, 4, 2
    v_xor_b32 v4, v4, v2
    v_lshl_add_u32 v4, v4, 4, v8
    v_add_u32 v15, 3072, v4
    s_mul_i32 s24, s3, 6144
    s_mul_i32 s34, s3, -4608
    s_add_u32 s34, s34, 19456
    s_add_u32 s31, s24, 153600
    buffer_load_dwordx4 v[244:247], v7, s[8:11], s26 offen offset:1024 nt
    s_mov_b32 s18, 452984832
    s_mov_b32 s19, 0x20000
    s_mov_b32 s22, 256
    s_mov_b32 s23, 0x20000
    s_mov_b32 s61, 2000000
    v_lshrrev_b32 v2, 5, v0
    v_bfe_u32 v3, v0, 2, 2
    v_bfe_u32 v4, v0, 4, 1
    v_and_b32 v5, 1, v0
    v_lshl_or_b32 v4, v4, 1, v5
    v_lshl_or_b32 v4, v3, 2, v4
    v_bfe_u32 v5, v0, 1, 1
    v_lshlrev_b32 v5, 3, v5
    v_lshl_add_u32 v35, v2, 2, v3
    v_mul_u32_u24 v35, 768, v35
    v_add_u32 v35, v35, v5
    v_add_u32 v35, 24576, v35
    v_lshlrev_b32 v39, 1, v2
    buffer_load_dwordx4 v[248:251], v6, s[12:15], s27 offen nt
    v_lshrrev_b32 v36, 1, v3
    v_lshlrev_b32 v36, 4, v36
    v_lshl_add_u32 v36, v2, 2, v36
    v_and_or_b32 v36, v3, 1, v36
    v_mul_u32_u24 v36, 768, v36
    v_add_u32 v36, v36, v5
    v_lshlrev_b32 v37, 2, v2
    s_mov_b32 s30, 0x78
    v_lshrrev_b32 v37, v37, s30
    v_bfe_u32 v38, v37, 2, 2
    v_and_b32 v37, 3, v37
    s_mul_i32 s30, s3, 12
    s_add_u32 s30, s30, 0
    v_xor_b32 v32, s30, v4
    v_xor_b32 v33, v32, v39
    v_lshl_add_u32 v24, v33, 4, v35
    s_mov_b32 exec_hi, 0
    buffer_load_dwordx4 v[252:255], v6, s[12:15], s27 offen offset:1024 nt
    s_mov_b32 exec_hi, -1
    v_xor_b32 v33, v32, v37
    v_lshl_add_u32 v18, v33, 4, v36
    v_xor_b32 v33, v32, v38
    v_lshl_add_u32 v33, v33, 4, v36
    v_add_u32 v19, 1536, v33
    s_mul_i32 s30, s3, 12
    s_add_u32 s30, s30, 4
    v_xor_b32 v32, s30, v4
    v_xor_b32 v33, v32, v39
    v_lshl_add_u32 v25, v33, 4, v35
    v_xor_b32 v33, v32, v37
    v_lshl_add_u32 v20, v33, 4, v36
    v_xor_b32 v33, v32, v38
    v_lshl_add_u32 v33, v33, 4, v36
    v_add_u32 v21, 1536, v33
    s_mul_i32 s30, s3, 12
    s_add_u32 s30, s30, 8
    v_xor_b32 v32, s30, v4
    v_xor_b32 v33, v32, v39
    v_lshl_add_u32 v26, v33, 4, v35
    s_add_u32 s26, s26, 4718592
    s_add_u32 s27, s27, 1179648
    s_mov_b32 m0, s24
    s_nop 0
    buffer_load_dwordx4 v10, s[8:11], s26 offen nt lds
    v_xor_b32 v33, v32, v37
    v_lshl_add_u32 v22, v33, 4, v36
    v_xor_b32 v33, v32, v38
    v_lshl_add_u32 v33, v33, 4, v36
    v_add_u32 v23, 1536, v33
    v_add_u32 v27, 153600, v6
    v_lshlrev_b32 v1, 3, v0
    v_lshlrev_b32 v8, 7, v0
    v_and_b32 v31, 1, v0
    v_lshlrev_b32 v31, 7, v31
    v_mov_b64 v[128:129], 0
    v_mov_b64 v[130:131], 0
    v_mov_b64 v[132:133], 0
    v_mov_b64 v[134:135], 0
    v_mov_b64 v[136:137], 0
    v_mov_b64 v[138:139], 0
    s_add_u32 m0, m0, 1024
    s_nop 0
    buffer_load_dwordx4 v11, s[8:11], s26 offen nt lds
    v_mov_b64 v[140:141], 0
    v_mov_b64 v[142:143], 0
    v_mov_b64 v[144:145], 0
    v_mov_b64 v[146:147], 0
    v_mov_b64 v[148:149], 0
    v_mov_b64 v[150:151], 0
    v_mov_b64 v[152:153], 0
    v_mov_b64 v[154:155], 0
    v_mov_b64 v[156:157], 0
    v_mov_b64 v[158:159], 0
    v_mov_b64 v[160:161], 0
    v_mov_b64 v[162:163], 0
    v_mov_b64 v[164:165], 0
    v_mov_b64 v[166:167], 0
    v_mov_b64 v[168:169], 0
    v_mov_b64 v[170:171], 0
    s_add_u32 m0, m0, 1024
    s_nop 0
    buffer_load_dwordx4 v12, s[8:11], s26 offen nt lds
    v_mov_b64 v[172:173], 0
    v_mov_b64 v[174:175], 0
    v_mov_b64 v[176:177], 0
    v_mov_b64 v[178:179], 0
    v_mov_b64 v[180:181], 0
    v_mov_b64 v[182:183], 0
    v_mov_b64 v[184:185], 0
    v_mov_b64 v[186:187], 0
    v_mov_b64 v[188:189], 0
    v_mov_b64 v[190:191], 0
    v_mov_b64 v[192:193], 0
    v_mov_b64 v[194:195], 0
    v_mov_b64 v[196:197], 0
    v_mov_b64 v[198:199], 0
    v_mov_b64 v[200:201], 0
    v_mov_b64 v[202:203], 0
    s_add_u32 m0, m0, 1024
    s_nop 0
    buffer_load_dwordx4 v13, s[8:11], s26 offen nt lds
    v_mov_b64 v[204:205], 0
    v_mov_b64 v[206:207], 0
    v_mov_b64 v[208:209], 0
    v_mov_b64 v[210:211], 0
    v_mov_b64 v[212:213], 0
    v_mov_b64 v[214:215], 0
    v_mov_b64 v[216:217], 0
    v_mov_b64 v[218:219], 0
    v_mov_b64 v[220:221], 0
    v_mov_b64 v[222:223], 0
    v_mov_b32 v28, 0x41800000
    v_mov_b32 v29, 0
    v_mov_b32 v30, 0x3f803f80
    s_lshr_b32 s30, s6, 3
    s_and_b32 s30, s30, 3
    s_mov_b32 s44, 7
    s_cmp_eq_u32 s30, 1
    s_cselect_b32 s44, 4, s44
    s_cmp_eq_u32 s30, 2
    s_cselect_b32 s44, 1, s44
    s_cmp_eq_u32 s30, 3
    s_cselect_b32 s44, 2, s44
    s_add_u32 m0, m0, 1024
    s_nop 0
    buffer_load_dwordx4 v14, s[8:11], s26 offen nt lds
    s_mov_b64 s[28:29], -1
    s_mov_b32 s45, 0
    s_mov_b32 s25, 0
    s_mov_b32 s33, 61440
    s_mov_b32 s49, 0
    s_mov_b32 s58, 2
    v_mov_b32 v2, 158976
    s_bfe_u32 s36, s6, 0x10002
    s_mul_i32 s36, s36, 3
    s_and_b32 s30, s6, 3
    s_add_u32 s36, s36, s30
    s_sub_u32 s36, s36, 1
    s_lshr_b32 s37, s6, 3
    s_mul_i32 s38, s36, 1605632
    s_add_u32 s38, s38, 2097152
    s_lshl_b32 s39, s36, 7
    s_add_u32 s39, s39, 623616
    s_add_u32 m0, m0, 1024
    s_nop 0
    buffer_load_dwordx4 v15, s[8:11], s26 offen nt lds
    s_mul_i32 s52, s37, 50176
    s_add_u32 s52, s52, s38
    s_lshl_b32 s30, s3, 8
    s_add_u32 s48, s52, s30
    s_add_u32 s48, s48, 49152
    s_mul_i32 s30, s3, 12544
    s_add_u32 s50, s52, s30
    s_mul_i32 s30, s3, 6144
    s_add_u32 s52, s52, s30
    s_add_u32 s53, s52, 4096
    s_add_u32 s54, s52, 24576
    s_add_u32 s55, s52, 28672
    s_lshl_b32 s51, s36, 2
    s_add_u32 s51, s51, s3
    s_lshl_b32 s51, s51, 5
    s_add_u32 s51, s51, s37
    s_lshl_b32 s51, s51, 2
    s_add_u32 s51, s51, 577536
    s_add_u32 m0, m0, s34
    s_nop 0
    buffer_load_dwordx4 v16, s[12:15], s27 offen nt lds
    s_add_u32 m0, m0, 1024
    s_mov_b32 exec_hi, 0
    buffer_load_dwordx4 v17, s[12:15], s27 offen nt lds
    s_mov_b32 exec_hi, -1
    s_add_u32 s26, s26, 4718592
    s_add_u32 s27, s27, 1179648
    s_add_u32 s24, s24, 30720
    s_mov_b32 m0, s24
    s_nop 0
    buffer_load_dwordx4 v10, s[8:11], s26 offen nt lds
    s_add_u32 m0, m0, 1024
    s_nop 0
    buffer_load_dwordx4 v11, s[8:11], s26 offen nt lds
    s_add_u32 m0, m0, 1024
    s_nop 0
    buffer_load_dwordx4 v12, s[8:11], s26 offen nt lds
    s_add_u32 m0, m0, 1024
    s_nop 0
    buffer_load_dwordx4 v13, s[8:11], s26 offen nt lds
    s_add_u32 m0, m0, 1024
    s_nop 0
    buffer_load_dwordx4 v14, s[8:11], s26 offen nt lds
    s_add_u32 m0, m0, 1024
    s_nop 0
    buffer_load_dwordx4 v15, s[8:11], s26 offen nt lds
    s_add_u32 m0, m0, s34
    s_nop 0
    buffer_load_dwordx4 v16, s[12:15], s27 offen nt lds
    s_barrier
    s_add_u32 m0, m0, 1024
    s_mov_b32 exec_hi, 0
    buffer_load_dwordx4 v17, s[12:15], s27 offen nt lds
    s_mov_b32 exec_hi, -1
    s_lshl1_add_u32 s27, s35, 768
    s_mul_hi_u32 s30, s27, 178956971
    s_mul_i32 s30, s30, 24
    s_add_u32 s26, s27, s30
    s_lshl1_add_u32 s26, s26, s42
    s_mulk_i32 s26, 6144
    s_lshl2_add_u32 s27, s27, s3
    s_mulk_i32 s27, 1536
    s_add_u32 s24, s24, 30720
    s_mov_b32 m0, s24
    s_nop 0
    buffer_load_dwordx4 v10, s[8:11], s26 offen nt lds
    s_add_u32 m0, m0, 1024
    s_nop 0
    buffer_load_dwordx4 v11, s[8:11], s26 offen nt lds
    s_add_u32 m0, m0, 1024
    s_nop 0
    buffer_load_dwordx4 v12, s[8:11], s26 offen nt lds
    s_add_u32 m0, m0, 1024
    s_nop 0
    buffer_load_dwordx4 v13, s[8:11], s26 offen nt lds
    s_add_u32 m0, m0, 1024
    s_nop 0
    buffer_load_dwordx4 v14, s[8:11], s26 offen nt lds
    s_add_u32 m0, m0, 1024
    s_nop 0
    buffer_load_dwordx4 v15, s[8:11], s26 offen nt lds
    s_add_u32 m0, m0, s34
    s_nop 0
    buffer_load_dwordx4 v16, s[12:15], s27 offen nt lds
    s_add_u32 m0, m0, 1024
    s_mov_b32 exec_hi, 0
    buffer_load_dwordx4 v17, s[12:15], s27 offen nt lds
    s_mov_b32 exec_hi, -1
    s_add_u32 s26, s26, 9437184
    s_add_u32 s27, s27, 2359296
    s_add_u32 s24, s24, 61440
Lw_0:
    s_cbranch_execz Lw_4
    v_add_u32 v124, 30720, v18
    v_add_u32 v125, 30720, v19
    v_add_u32 v126, 30720, v20
    v_add_u32 v127, 30720, v21
    v_add_u32 v4, 30720, v22
    v_add_u32 v5, 30720, v23
    v_add_u32 v7, 30720, v24
    v_add_u32 v9, 30720, v25
    v_add_u32 v39, 30720, v26
    s_sub_u32 s40, s24, 30720
    s_setprio 1
    s_barrier
    s_waitcnt vmcnt(8)
    s_barrier
    s_mov_b32 m0, s24
    s_nop 0
    buffer_load_dwordx4 v10, s[8:11], s26 offen nt lds
    v_add_u32 v32, s40, v10
    ds_write_b128 v32, v[40:43]
    s_add_u32 m0, m0, 1024
    s_nop 0
    buffer_load_dwordx4 v11, s[8:11], s26 offen nt lds
    v_add_u32 v33, s40, v11
    ds_write_b128 v33, v[44:47]
    s_add_u32 m0, m0, 1024
    s_nop 0
    buffer_load_dwordx4 v12, s[8:11], s26 offen nt lds
    v_add_u32 v32, s40, v12
    ds_write_b128 v32, v[48:51]
    s_add_u32 m0, m0, 1024
    s_nop 0
    buffer_load_dwordx4 v13, s[8:11], s26 offen nt lds
    v_add_u32 v33, s40, v13
    ds_write_b128 v33, v[52:55]
    s_add_u32 m0, m0, 1024
    s_nop 0
    buffer_load_dwordx4 v14, s[8:11], s26 offen nt lds
    v_add_u32 v32, s40, v14
    ds_write_b128 v32, v[56:59]
    s_add_u32 m0, m0, 1024
    s_nop 0
    buffer_load_dwordx4 v15, s[8:11], s26 offen nt lds
    v_add_u32 v33, s40, v15
    ds_write_b128 v33, v[60:63]
    s_add_u32 m0, m0, s34
    s_nop 0
    buffer_load_dwordx4 v16, s[12:15], s27 offen nt lds
    s_add_u32 s43, s40, s34
    s_add_u32 s43, s43, 5120
    v_add_u32 v32, s43, v16
    ds_write_b128 v32, v[64:67]
    s_add_u32 m0, m0, 1024
    s_mov_b32 exec_hi, 0
    buffer_load_dwordx4 v17, s[12:15], s27 offen nt lds
    s_mov_b32 exec_hi, -1
    v_add_u32 v33, s43, v17
    s_mov_b32 exec_hi, 0
    ds_write_b128 v33, v[68:71]
    s_mov_b32 exec_hi, -1
    s_add_u32 s26, s26, 9437184
    s_add_u32 s27, s27, 2359296
    s_mov_b64 vcc, 0
    s_waitcnt lgkmcnt(0)
    s_branch L_p_rd
.p2align 3
L_p:
    s_waitcnt vmcnt(8)
    s_cmp_eq_u32 s58, 2
    s_cbranch_scc0 L_p_w
L_p_wb:
    s_barrier
    ds_read_b32 v3, v2
    s_mov_b64 vcc, 0
    v_mfma_f32_32x32x16_bf16 v[144:159], v[72:75], v[112:115], v[144:159]
    v_mfma_f32_32x32x16_bf16 v[144:159], v[76:79], v[116:119], v[144:159]
    v_mfma_f32_32x32x16_bf16 v[160:175], v[80:83], v[112:115], v[160:175]
    v_mfma_f32_32x32x16_bf16 v[160:175], v[84:87], v[116:119], v[160:175]
    s_bitcmp1_b32 4294966816, s25
    s_cbranch_scc1 L_p_x1
L_p_go:
    s_cmp_lg_u32 s25, s44
    s_cselect_b32 s58, 2, 0
    s_cbranch_scc0 L_p_cu
    s_mov_b64 vcc, -1
    s_mov_b32 m0, s24
    s_nop 0
    buffer_load_dwordx4 v10, s[8:11], s26 offen nt lds
    s_add_u32 m0, m0, 1024
    s_nop 0
    buffer_load_dwordx4 v11, s[8:11], s26 offen nt lds
    s_add_u32 m0, m0, 1024
    s_nop 0
    buffer_load_dwordx4 v12, s[8:11], s26 offen nt lds
    s_add_u32 m0, m0, 1024
    s_nop 0
    buffer_load_dwordx4 v13, s[8:11], s26 offen nt lds
    s_add_u32 m0, m0, 1024
    s_nop 0
    buffer_load_dwordx4 v14, s[8:11], s26 offen nt lds
    s_add_u32 m0, m0, 1024
    s_nop 0
    buffer_load_dwordx4 v15, s[8:11], s26 offen nt lds
    s_add_u32 m0, m0, s34
    s_nop 0
Lw_1:
    s_cbranch_execz Lw_5
    buffer_load_dwordx4 v16, s[12:15], s27 offen nt lds
    s_add_u32 m0, m0, 1024
    s_mov_b32 exec_hi, 0
    buffer_load_dwordx4 v17, s[12:15], s27 offen nt lds
    s_mov_b32 exec_hi, -1
    s_add_u32 s26, s26, 9437184
    s_add_u32 s27, s27, 2359296
L_p_rd:
    s_setprio 0
    ds_read_b64_tr_b16 v[88:89], v24
    ds_read_b64_tr_b16 v[40:41], v18 offset:0
    ds_read_b64_tr_b16 v[42:43], v19 offset:0
    ds_read_b64_tr_b16 v[44:45], v18 offset:6144
    ds_read_b64_tr_b16 v[46:47], v19 offset:6144
    ds_read_b64_tr_b16 v[92:93], v25
    ds_read_b64_tr_b16 v[48:49], v20 offset:0
    ds_read_b64_tr_b16 v[50:51], v21 offset:0
    ds_read_b64_tr_b16 v[52:53], v20 offset:6144
    ds_read_b64_tr_b16 v[54:55], v21 offset:6144
    ds_read_b64_tr_b16 v[96:97], v26
    ds_read_b64_tr_b16 v[56:57], v22 offset:0
    ds_read_b64_tr_b16 v[58:59], v23 offset:0
    s_waitcnt lgkmcnt(8)
    ds_read_b64_tr_b16 v[60:61], v22 offset:6144
    ds_read_b64_tr_b16 v[62:63], v23 offset:6144
    ds_read_b64_tr_b16 v[90:91], v7
    ds_read_b64_tr_b16 v[94:95], v9
    ds_read_b64_tr_b16 v[98:99], v39
    s_cmp_ge_u32 s45, 3
    s_cselect_b32 s32, -92160, s33
    s_cselect_b32 s30, -3, 2
    s_bitcmp1_b32 12, s45
    s_cselect_b32 s41, -92160, s33
    s_add_u32 s45, s45, s30
    s_setprio 1
    s_waitcnt lgkmcnt(0)
    s_barrier
    ds_read_b128 v[100:103], v27 offset:4096
    ds_read_b128 v[104:107], v27 offset:0
    ds_read_b128 v[108:111], v27 offset:1024
    ds_read_b128 v[112:115], v27 offset:2048
    ds_read_b128 v[116:119], v27 offset:3072
    s_waitcnt lgkmcnt(4)
    v_or3_b32 v32, v100, v101, v102
    v_or_b32 v32, v32, v103
    v_and_b32 v32, 0x40004000, v32
    v_cmp_ne_u32 vcc, 0, v32
    s_or_b64 vcc, vcc, s[28:29]
    s_cbranch_scc1 L_p_slow
L_p_back:
    s_cmp_eq_u32 s49, 2
    s_cbranch_scc1 L_p_last
    v_dot2c_f32_bf16 v29, v100, v30
    v_dot2c_f32_bf16 v29, v101, v30
    v_dot2c_f32_bf16 v29, v102, v30
    v_dot2c_f32_bf16 v29, v103, v30
    s_cmp_eq_u32 s25, s44
    s_cselect_b64 vcc, -1, 0
    v_mfma_f32_32x32x16_bf16 v[176:191], v[88:91], v[100:103], v[176:191]
    ds_read_b64_tr_b16 v[64:65], v124 offset:0
    ds_read_b64_tr_b16 v[66:67], v125 offset:0
    v_add_u32 v18, s32, v18
    v_add_u32 v19, s32, v19
    v_mfma_f32_32x32x16_bf16 v[192:207], v[92:95], v[100:103], v[192:207]
    ds_read_b64_tr_b16 v[68:69], v124 offset:6144
    ds_read_b64_tr_b16 v[70:71], v125 offset:6144
    v_add_u32 v20, s32, v20
    v_add_u32 v21, s32, v21
    s_cbranch_vccnz L_un_1
L_un_1_b:
    v_mfma_f32_32x32x16_bf16 v[208:223], v[96:99], v[100:103], v[208:223]
    ds_read_b64_tr_b16 v[72:73], v126 offset:0
    ds_read_b64_tr_b16 v[74:75], v127 offset:0
    v_add_u32 v22, s32, v22
    v_add_u32 v23, s32, v23
    s_waitcnt lgkmcnt(9)
    v_mfma_f32_32x32x16_bf16 v[128:143], v[40:43], v[104:107], v[128:143]
    ds_read_b64_tr_b16 v[76:77], v126 offset:6144
    ds_read_b64_tr_b16 v[78:79], v127 offset:6144
    v_add_u32 v24, s32, v24
    v_add_u32 v25, s32, v25
    s_cbranch_vccnz L_un_2
L_un_2_b:
    s_waitcnt lgkmcnt(10)
    v_mfma_f32_32x32x16_bf16 v[128:143], v[44:47], v[108:111], v[128:143]
    ds_read_b64_tr_b16 v[80:81], v4 offset:0
    ds_read_b64_tr_b16 v[82:83], v5 offset:0
    v_add_u32 v26, s32, v26
    v_mfma_f32_32x32x16_bf16 v[144:159], v[48:51], v[104:107], v[144:159]
    ds_read_b64_tr_b16 v[84:85], v4 offset:6144
    ds_read_b64_tr_b16 v[86:87], v5 offset:6144
    s_cbranch_vccnz L_un_3
L_un_3_b:
    v_mfma_f32_32x32x16_bf16 v[144:159], v[52:55], v[108:111], v[144:159]
    v_add_u32 v124, s41, v124
    v_add_u32 v125, s41, v125
    v_mfma_f32_32x32x16_bf16 v[160:175], v[56:59], v[104:107], v[160:175]
    v_add_u32 v126, s41, v126
    v_add_u32 v127, s41, v127
    s_cbranch_vccnz L_un_4
L_un_4_b:
    v_mfma_f32_32x32x16_bf16 v[160:175], v[60:63], v[108:111], v[160:175]
    v_add_u32 v4, s41, v4
    v_add_u32 v5, s41, v5
    s_waitcnt lgkmcnt(0)
    v_mfma_f32_32x32x16_bf16 v[128:143], v[64:67], v[112:115], v[128:143]
Lw_2:
    s_cbranch_execz Lw_6
    v_add_u32 v7, s41, v7
    v_add_u32 v9, s41, v9
    v_mfma_f32_32x32x16_bf16 v[128:143], v[68:71], v[116:119], v[128:143]
    v_add_u32 v39, s41, v39
    s_add_u32 s24, s24, 61440
    s_cmp_ge_u32 s24, s31
    s_cselect_b32 s30, 153600, 0
    s_sub_u32 s24, s24, s30
    s_add_u32 s25, s25, 1
    s_min_u32 s25, s25, 31
    s_branch L_p
L_p_x1:
    s_cmp_eq_u32 s25, 5
    s_cbranch_scc1 L_p_x0
    s_cmp_lg_u32 s49, 0
    s_cbranch_scc1 L_p_dry2
    s_waitcnt lgkmcnt(0)
    v_readfirstlane_b32 s27, v3
    s_cmp_lt_i32 s27, 0
    s_cbranch_scc1 L_p_dry
    s_bitset0_b32 s27, 30
    s_mul_hi_u32 s30, s27, 178956971
    s_mul_i32 s30, s30, 24
    s_add_u32 s26, s27, s30
    s_lshl1_add_u32 s26, s26, s42
    s_mulk_i32 s26, 6144
    s_lshl2_add_u32 s27, s27, s3
    s_mulk_i32 s27, 1536
    s_branch L_p_go
L_p_dry:
    s_bfm_b64 exec, 49, 0
    buffer_load_dword v38, v8, s[16:19], s50 offen
    s_add_u32 s50, s50, 6272
    s_mov_b64 exec, -1
L_lw_5:
    v_and_b32 v122, v122, v123
    v_cmp_eq_u32 vcc, 0, v122
    s_and_b32 s30, vcc_lo, 3
    s_cbranch_scc1 L_lw_5_r
L_lw_5_d:
L_xg:
    v_lshl_add_u64 v[120:121], v[120:121], 0, 1
    v_add_u32 v32, v120, v121
    s_nop 0
    v_readfirstlane_b32 s30, v32
    s_mul_i32 s30, s30, 0x01010101
    s_lshr_b32 s30, s30, 24
    s_cmp_ge_u32 s30, 32
    s_cbranch_scc0 L_xgr
L_xgd:
    v_readfirstlane_b32 s56, v120
    v_readfirstlane_b32 s57, v121
    s_getreg_b32 s30, hwreg(HW_REG_XCC_ID, 0, 4)
    s_lshl_b32 s30, s30, 3
    s_lshr_b64 s[56:57], s[56:57], s30
    s_and_b32 s56, s56, 0xff
    s_cmp_eq_u32 s56, 32
    s_cselect_b32 s59, 1, 0
    s_cmp_lt_u32 s30, 64
    s_cselect_b32 s59, s59, 0
    s_mov_b32 s49, 1
    s_mov_b32 s58, 1
    s_mov_b64 vcc, 0
    s_branch L_p_rd
L_p_dry2:
    s_bfm_b64 exec, 49, 0
    buffer_load_dword v38, v8, s[16:19], s50 offen
    s_add_u32 s50, s50, 6272
    s_mov_b64 exec, -1
    s_mov_b32 s49, 2
    s_branch L_p_rd
L_p_x0:
    s_mov_b64 exec, 3
    buffer_load_dwordx2 v[122:123], v31, s[20:23], 0 offen offset:16 sc1
    s_mov_b64 exec, -1
    s_mov_b64 exec, 1
    buffer_load_dwordx2 v[120:121], off, s[16:19], s39 sc1
    s_mov_b64 exec, -1
    s_branch L_p_go
L_p_w:
    s_waitcnt vmcnt(1)
    s_cmp_eq_u32 s58, 1
    s_cbranch_scc1 L_p_wb
    s_waitcnt vmcnt(0)
    s_branch L_p_wb
L_p_cu:
    s_branch L_p_rd
L_un_1:
    s_waitcnt lgkmcnt(8)
    v_add_u32 v32, s24, v10
    ds_write_b128 v32, v[224:227]
    v_add_u32 v33, s24, v11
    ds_write_b128 v33, v[228:231]
    s_branch L_un_1_b
L_un_2:
    s_waitcnt lgkmcnt(8)
    v_add_u32 v32, s24, v12
    ds_write_b128 v32, v[232:235]
    v_add_u32 v33, s24, v13
    ds_write_b128 v33, v[236:239]
    s_branch L_un_2_b
L_un_3:
    s_waitcnt lgkmcnt(8)
    v_add_u32 v32, s24, v14
    ds_write_b128 v32, v[240:243]
    v_add_u32 v33, s24, v15
    ds_write_b128 v33, v[244:247]
    s_branch L_un_3_b
L_un_4:
    s_waitcnt lgkmcnt(8)
    s_add_u32 s43, s24, s34
    s_add_u32 s43, s43, 5120
    v_add_u32 v32, s43, v16
    ds_write_b128 v32, v[248:251]
Lw_3:
    s_cbranch_execz Lw_7
    v_add_u32 v33, s43, v17
    s_mov_b32 exec_hi, 0
    ds_write_b128 v33, v[252:255]
    s_mov_b32 exec_hi, -1
    s_branch L_un_4_b
L_lw_5_r:
    s_sleep 8
    s_mov_b64 exec, 3
    buffer_load_dwordx2 v[122:123], v31, s[20:23], 0 offen offset:16 sc1
    s_mov_b64 exec, -1
    s_waitcnt vmcnt(0)
    s_sub_u32 s61, s61, 1
    s_cmp_gt_i32 s61, 0
    s_cbranch_scc1 L_lw_5
    s_branch L_lw_5_d
L_xgr:
    s_sleep 8
    s_mov_b64 exec, 1
    buffer_load_dwordx2 v[120:121], off, s[16:19], s39 sc1
    s_mov_b64 exec, -1
    s_waitcnt vmcnt(0)
    s_sub_u32 s61, s61, 1
    s_cmp_gt_i32 s61, 0
    s_cbranch_scc1 L_xg
    s_branch L_xgd
L_p_last:
    v_mfma_f32_32x32x16_bf16 v[176:191], v[88:91], v[100:103], v[176:191]
    ds_read_b64_tr_b16 v[64:65], v124 offset:0
    ds_read_b64_tr_b16 v[66:67], v125 offset:0
    ds_read_b64_tr_b16 v[68:69], v124 offset:6144
    v_mfma_f32_32x32x16_bf16 v[192:207], v[92:95], v[100:103], v[192:207]
    ds_read_b64_tr_b16 v[70:71], v125 offset:6144
    ds_read_b64_tr_b16 v[72:73], v126 offset:0
    ds_read_b64_tr_b16 v[74:75], v127 offset:0
    v_mfma_f32_32x32x16_bf16 v[208:223], v[96:99], v[100:103], v[208:223]
    ds_read_b64_tr_b16 v[76:77], v126 offset:6144
    ds_read_b64_tr_b16 v[78:79], v127 offset:6144
    ds_read_b64_tr_b16 v[80:81], v4 offset:0
    v_lshlrev_b32 v32, 16, v100
    v_and_b32 v33, 0xffff0000, v100
    v_add_f32 v29, v29, v32
    v_add_f32 v29, v29, v33
    v_lshlrev_b32 v32, 16, v101
    v_and_b32 v33, 0xffff0000, v101
    v_add_f32 v29, v29, v32
    v_add_f32 v29, v29, v33
    s_waitcnt lgkmcnt(9)
    v_mfma_f32_32x32x16_bf16 v[128:143], v[40:43], v[104:107], v[128:143]
    ds_read_b64_tr_b16 v[82:83], v5 offset:0
    ds_read_b64_tr_b16 v[84:85], v4 offset:6144
    ds_read_b64_tr_b16 v[86:87], v5 offset:6144
    v_lshlrev_b32 v32, 16, v102
    v_and_b32 v33, 0xffff0000, v102
    v_add_f32 v29, v29, v32
    v_add_f32 v29, v29, v33
    v_lshlrev_b32 v32, 16, v103
    v_and_b32 v33, 0xffff0000, v103
    v_add_f32 v29, v29, v32
    v_add_f32 v29, v29, v33
    v_mfma_f32_32x32x16_bf16 v[128:143], v[44:47], v[108:111], v[128:143]
    v_cvt_pk_bf16_f32 v176, v176, v177
    v_cvt_pk_bf16_f32 v177, v178, v179
    v_cvt_pk_bf16_f32 v178, v180, v181
    v_cvt_pk_bf16_f32 v179, v182, v183
    buffer_store_dwordx4 v[176:179], v6, s[16:19], s54 offen offset:0
    s_waitcnt lgkmcnt(0)
    v_mfma_f32_32x32x16_bf16 v[128:143], v[64:67], v[112:115], v[128:143]
    v_cvt_pk_bf16_f32 v184, v184, v185
    v_cvt_pk_bf16_f32 v185, v186, v187
    v_cvt_pk_bf16_f32 v186, v188, v189
    v_cvt_pk_bf16_f32 v187, v190, v191
    buffer_store_dwordx4 v[184:187], v6, s[16:19], s54 offen offset:1024
    v_mfma_f32_32x32x16_bf16 v[128:143], v[68:71], v[116:119], v[128:143]
    v_cvt_pk_bf16_f32 v192, v192, v193
    v_cvt_pk_bf16_f32 v193, v194, v195
    v_cvt_pk_bf16_f32 v194, v196, v197
    v_cvt_pk_bf16_f32 v195, v198, v199
    buffer_store_dwordx4 v[192:195], v6, s[16:19], s54 offen offset:2048
    v_mfma_f32_32x32x16_bf16 v[144:159], v[48:51], v[104:107], v[144:159]
    v_cvt_pk_bf16_f32 v200, v200, v201
    v_cvt_pk_bf16_f32 v201, v202, v203
    v_cvt_pk_bf16_f32 v202, v204, v205
    v_cvt_pk_bf16_f32 v203, v206, v207
    buffer_store_dwordx4 v[200:203], v6, s[16:19], s54 offen offset:3072
    v_mfma_f32_32x32x16_bf16 v[144:159], v[52:55], v[108:111], v[144:159]
    v_cvt_pk_bf16_f32 v208, v208, v209
    v_cvt_pk_bf16_f32 v209, v210, v211
    v_cvt_pk_bf16_f32 v210, v212, v213
    v_cvt_pk_bf16_f32 v211, v214, v215
    buffer_store_dwordx4 v[208:211], v6, s[16:19], s55 offen offset:0
    v_mfma_f32_32x32x16_bf16 v[144:159], v[72:75], v[112:115], v[144:159]
    v_cvt_pk_bf16_f32 v216, v216, v217
    v_cvt_pk_bf16_f32 v217, v218, v219
    v_cvt_pk_bf16_f32 v218, v220, v221
    v_cvt_pk_bf16_f32 v219, v222, v223
    buffer_store_dwordx4 v[216:219], v6, s[16:19], s55 offen offset:1024
    v_mfma_f32_32x32x16_bf16 v[144:159], v[76:79], v[116:119], v[144:159]
    v_cvt_pk_bf16_f32 v128, v128, v129
    v_cvt_pk_bf16_f32 v129, v130, v131
    v_cvt_pk_bf16_f32 v130, v132, v133
    v_cvt_pk_bf16_f32 v131, v134, v135
    buffer_store_dwordx4 v[128:131], v6, s[16:19], s52 offen offset:0
    v_mfma_f32_32x32x16_bf16 v[160:175], v[56:59], v[104:107], v[160:175]
Lw_4:
    s_cbranch_execz Lw_8
    v_cvt_pk_bf16_f32 v136, v136, v137
    v_cvt_pk_bf16_f32 v137, v138, v139
    v_cvt_pk_bf16_f32 v138, v140, v141
    v_cvt_pk_bf16_f32 v139, v142, v143
    buffer_store_dwordx4 v[136:139], v6, s[16:19], s52 offen offset:1024
    s_barrier
    v_mfma_f32_32x32x16_bf16 v[160:175], v[60:63], v[108:111], v[160:175]
    v_mov_b32 v32, v29
    v_readfirstlane_b32 s57, v28
    s_nop 0
    v_permlane32_swap_b32 v29, v32
    v_add_f32 v29, v29, v32
    v_cmp_neq_f32 vcc, s57, v28
    v_mfma_f32_32x32x16_bf16 v[160:175], v[80:83], v[112:115], v[160:175]
    s_mov_b32 exec_hi, 0
    buffer_store_dwordx2 v[28:29], v1, s[16:19], s48 offen
    s_mov_b32 exec_hi, -1
    v_mfma_f32_32x32x16_bf16 v[160:175], v[84:87], v[116:119], v[160:175]
    v_cvt_pk_bf16_f32 v144, v144, v145
    v_cvt_pk_bf16_f32 v145, v146, v147
    v_cvt_pk_bf16_f32 v146, v148, v149
    v_cvt_pk_bf16_f32 v147, v150, v151
    buffer_store_dwordx4 v[144:147], v6, s[16:19], s52 offen offset:2048
    v_cvt_pk_bf16_f32 v152, v152, v153
    v_cvt_pk_bf16_f32 v153, v154, v155
    v_cvt_pk_bf16_f32 v154, v156, v157
    v_cvt_pk_bf16_f32 v155, v158, v159
    buffer_store_dwordx4 v[152:155], v6, s[16:19], s52 offen offset:3072
    s_cmp_eq_u64 vcc, 0
    s_cselect_b32 s57, s57, -2
    v_mov_b32 v32, s57
    s_nop 0
    v_cvt_pk_bf16_f32 v160, v160, v161
    v_cvt_pk_bf16_f32 v161, v162, v163
    v_cvt_pk_bf16_f32 v162, v164, v165
    v_cvt_pk_bf16_f32 v163, v166, v167
    buffer_store_dwordx4 v[160:163], v6, s[16:19], s53 offen offset:0
    v_cvt_pk_bf16_f32 v168, v168, v169
    v_cvt_pk_bf16_f32 v169, v170, v171
    v_cvt_pk_bf16_f32 v170, v172, v173
    v_cvt_pk_bf16_f32 v171, v174, v175
    buffer_store_dwordx4 v[168:171], v6, s[16:19], s53 offen offset:1024
    s_cmp_eq_u32 s59, 0
    s_waitcnt vmcnt(0)
    s_cbranch_scc1 L_p_far
    s_mov_b64 exec, 1
    buffer_store_dword v32, off, s[16:19], s51
    s_branch L_fin
L_p_far:
    buffer_store_dwordx4 v[128:131], v6, s[16:19], s52 offen offset:0 sc1
    buffer_store_dwordx4 v[136:139], v6, s[16:19], s52 offen offset:1024 sc1
    buffer_store_dwordx4 v[144:147], v6, s[16:19], s52 offen offset:2048 sc1
    buffer_store_dwordx4 v[152:155], v6, s[16:19], s52 offen offset:3072 sc1
    buffer_store_dwordx4 v[160:163], v6, s[16:19], s53 offen offset:0 sc1
    buffer_store_dwordx4 v[168:171], v6, s[16:19], s53 offen offset:1024 sc1
    buffer_store_dwordx4 v[176:179], v6, s[16:19], s54 offen offset:0 sc1
    buffer_store_dwordx4 v[184:187], v6, s[16:19], s54 offen offset:1024 sc1
    buffer_store_dwordx4 v[192:195], v6, s[16:19], s54 offen offset:2048 sc1
    buffer_store_dwordx4 v[200:203], v6, s[16:19], s54 offen offset:3072 sc1
    buffer_store_dwordx4 v[208:211], v6, s[16:19], s55 offen offset:0 sc1
    buffer_store_dwordx4 v[216:219], v6, s[16:19], s55 offen offset:1024 sc1
    s_mov_b32 exec_hi, 0
    buffer_store_dwordx2 v[28:29], v1, s[16:19], s48 offen sc1
    s_mov_b32 exec_hi, -1
    s_waitcnt vmcnt(0)
    s_mov_b64 exec, 1
    buffer_store_dword v32, off, s[16:19], s51 sc1
    s_branch L_fin
L_p_slow:
    s_cmp_eq_u64 s[28:29], 0
    s_cbranch_scc1 L_pf_go
    v_cmp_ne_u32 s[56:57], 0, v32
    v_pk_max_u16 v32, v100, v101
    v_pk_max_u16 v33, v102, v103
    v_pk_max_u16 v32, v32, v33
    v_lshlrev_b32 v33, 16, v32
    v_max_u32 v32, v32, v33
    v_cmp_gt_u32 vcc, 0x2b800000, v32
    s_or_b64 vcc, vcc, s[56:57]
    s_cbranch_scc1 L_pf_go
    s_mov_b64 s[28:29], 0
    s_branch L_p_back
L_pf_go:
    s_mov_b32 s30, 158720
    v_and_b32 v34, 31, v0
    v_lshl_add_u32 v34, v34, 2, s30
    s_waitcnt lgkmcnt(0)
    s_barrier
    ds_read2_b32 v[32:33], v34 offset0:0 offset1:32
    s_waitcnt lgkmcnt(0)
    v_max_f32 v32, v32, v33
    v_add_f32 v32, 4.0, v32
    v_mul_f32 v32, 0x3d800000, v32
    v_ceil_f32 v32, v32
    v_mul_f32 v32, 0x41800000, v32
    s_cmp_lg_u64 s[28:29], 0
    s_cbranch_scc1 L_6
    v_max_f32 v32, 0, v32
    v_exp_f32 v34, -v32
    s_nop 0
    v_mul_f32 v29, v29, v34
    v_pk_mul_f32 v[128:129], v[128:129], v[34:35] op_sel_hi:[1,0]
    v_pk_mul_f32 v[130:131], v[130:131], v[34:35] op_sel_hi:[1,0]
Lw_5:
    s_cbranch_execz Lw_9
    v_pk_mul_f32 v[132:133], v[132:133], v[34:35] op_sel_hi:[1,0]
    v_pk_mul_f32 v[134:135], v[134:135], v[34:35] op_sel_hi:[1,0]
    v_pk_mul_f32 v[136:137], v[136:137], v[34:35] op_sel_hi:[1,0]
    v_pk_mul_f32 v[138:139], v[138:139], v[34:35] op_sel_hi:[1,0]
    v_pk_mul_f32 v[140:141], v[140:141], v[34:35] op_sel_hi:[1,0]
    v_pk_mul_f32 v[142:143], v[142:143], v[34:35] op_sel_hi:[1,0]
    v_pk_mul_f32 v[144:145], v[144:145], v[34:35] op_sel_hi:[1,0]
    v_pk_mul_f32 v[146:147], v[146:147], v[34:35] op_sel_hi:[1,0]
    v_pk_mul_f32 v[148:149], v[148:149], v[34:35] op_sel_hi:[1,0]
    v_pk_mul_f32 v[150:151], v[150:151], v[34:35] op_sel_hi:[1,0]
    v_pk_mul_f32 v[152:153], v[152:153], v[34:35] op_sel_hi:[1,0]
    v_pk_mul_f32 v[154:155], v[154:155], v[34:35] op_sel_hi:[1,0]
    v_pk_mul_f32 v[156:157], v[156:157], v[34:35] op_sel_hi:[1,0]
    v_pk_mul_f32 v[158:159], v[158:159], v[34:35] op_sel_hi:[1,0]
    v_pk_mul_f32 v[160:161], v[160:161], v[34:35] op_sel_hi:[1,0]
    v_pk_mul_f32 v[162:163], v[162:163], v[34:35] op_sel_hi:[1,0]
    v_pk_mul_f32 v[164:165], v[164:165], v[34:35] op_sel_hi:[1,0]
    v_pk_mul_f32 v[166:167], v[166:167], v[34:35] op_sel_hi:[1,0]
    v_pk_mul_f32 v[168:169], v[168:169], v[34:35] op_sel_hi:[1,0]
    v_pk_mul_f32 v[170:171], v[170:171], v[34:35] op_sel_hi:[1,0]
    v_pk_mul_f32 v[172:173], v[172:173], v[34:35] op_sel_hi:[1,0]
    v_pk_mul_f32 v[174:175], v[174:175], v[34:35] op_sel_hi:[1,0]
    v_pk_mul_f32 v[176:177], v[176:177], v[34:35] op_sel_hi:[1,0]
    v_pk_mul_f32 v[178:179], v[178:179], v[34:35] op_sel_hi:[1,0]
    v_pk_mul_f32 v[180:181], v[180:181], v[34:35] op_sel_hi:[1,0]
    v_pk_mul_f32 v[182:183], v[182:183], v[34:35] op_sel_hi:[1,0]
    v_pk_mul_f32 v[184:185], v[184:185], v[34:35] op_sel_hi:[1,0]
    v_pk_mul_f32 v[186:187], v[186:187], v[34:35] op_sel_hi:[1,0]
    v_pk_mul_f32 v[188:189], v[188:189], v[34:35] op_sel_hi:[1,0]
    v_pk_mul_f32 v[190:191], v[190:191], v[34:35] op_sel_hi:[1,0]
    v_pk_mul_f32 v[192:193], v[192:193], v[34:35] op_sel_hi:[1,0]
    v_pk_mul_f32 v[194:195], v[194:195], v[34:35] op_sel_hi:[1,0]
    v_pk_mul_f32 v[196:197], v[196:197], v[34:35] op_sel_hi:[1,0]
    v_pk_mul_f32 v[198:199], v[198:199], v[34:35] op_sel_hi:[1,0]
    v_pk_mul_f32 v[200:201], v[200:201], v[34:35] op_sel_hi:[1,0]
    v_pk_mul_f32 v[202:203], v[202:203], v[34:35] op_sel_hi:[1,0]
    v_pk_mul_f32 v[204:205], v[204:205], v[34:35] op_sel_hi:[1,0]
    v_pk_mul_f32 v[206:207], v[206:207], v[34:35] op_sel_hi:[1,0]
    v_pk_mul_f32 v[208:209], v[208:209], v[34:35] op_sel_hi:[1,0]
    v_pk_mul_f32 v[210:211], v[210:211], v[34:35] op_sel_hi:[1,0]
    v_pk_mul_f32 v[212:213], v[212:213], v[34:35] op_sel_hi:[1,0]
    v_pk_mul_f32 v[214:215], v[214:215], v[34:35] op_sel_hi:[1,0]
    v_pk_mul_f32 v[216:217], v[216:217], v[34:35] op_sel_hi:[1,0]
    v_pk_mul_f32 v[218:219], v[218:219], v[34:35] op_sel_hi:[1,0]
    v_pk_mul_f32 v[220:221], v[220:221], v[34:35] op_sel_hi:[1,0]
    v_pk_mul_f32 v[222:223], v[222:223], v[34:35] op_sel_hi:[1,0]
L_6:
    s_mov_b64 s[28:29], 0
    v_add_f32 v28, v28, v32
    s_barrier
    ds_read_b128 v[100:103], v27 offset:4096
    ds_read_b128 v[104:107], v27 offset:0
    ds_read_b128 v[108:111], v27 offset:1024
    ds_read_b128 v[112:115], v27 offset:2048
    ds_read_b128 v[116:119], v27 offset:3072
    s_waitcnt lgkmcnt(0)
    s_branch L_p_back
L_sw:
    s_lshl2_add_u32 s27, s35, s3
    s_mulk_i32 s27, 1536
    v_add_u32 v7, 4096, v6
    s_mov_b32 s14, 28311552
    s_mov_b32 s15, 0x20000
    s_add_u32 s2, s35, 64
    s_mov_b32 s18, 452984832
    s_mov_b32 s19, 0x20000
    s_mov_b32 s22, 256
    s_mov_b32 s23, 0x20000
    s_mov_b32 s61, 2000000
    s_cmp_lg_u32 s7, 0
    s_cbranch_scc1 L_snt
    s_getpc_b64 s[24:25]
L_pc_7:
    s_sub_u32 s24, s24, L_pc_7-standalone__detection_seg_detr_decoder__vision_kernel
    s_subb_u32 s25, s25, 0
    s_lshr_b32 s30, s6, 3
    s_mul_i32 s30, s30, 896
    v_lshl_add_u32 v2, v0, 7, s30
    s_mov_b64 exec, 127
    global_load_dword v55, v2, s[24:25]
    s_mov_b64 exec, -1
L_snt:
    s_lshl1_add_u32 s27, s35, 768
    s_add_u32 s27, s27, 1
    s_mul_hi_u32 s30, s27, 178956971
    s_mul_i32 s30, s30, 24
    s_add_u32 s26, s27, s30
    s_lshl1_add_u32 s26, s26, s42
    s_mulk_i32 s26, 6144
    s_lshl2_add_u32 s27, s27, s3
    s_mulk_i32 s27, 1536
    s_lshl_b32 s41, s4, 1
    s_lshl_b32 s44, s5, 1
    s_mov_b32 s47, 0x78
    v_add_u32 v2, 0, v0
    v_mul_u32_u24 v3, 1366, v2
    v_lshrrev_b32 v3, 16, v3
    v_mul_u32_u24 v4, 48, v3
    v_sub_u32 v2, v2, v4
    v_lshlrev_b32 v8, 4, v4
    v_add_lshl_u32 v4, v3, s41, 2
    v_or_b32 v4, s44, v4
    v_xor_b32 v4, v4, v2
    v_lshl_add_u32 v16, v4, 4, v8
    v_and_or_b32 v5, v3, 1, s44
    v_lshlrev_b32 v5, 2, v5
    v_xor_b32 v2, v2, v5
    v_and_b32 v3, 2, v3
    v_lshrrev_b32 v3, v3, s47
    v_and_b32 v4, 3, v3
    v_xor_b32 v4, v4, v2
    v_lshl_add_u32 v10, v4, 4, v8
    v_bfe_u32 v4, v3, 4, 2
    v_xor_b32 v4, v4, v2
    v_lshl_add_u32 v4, v4, 4, v8
    v_add_u32 v13, 3072, v4
    v_add_u32 v2, 64, v0
    v_mul_u32_u24 v3, 1366, v2
    v_lshrrev_b32 v3, 16, v3
    v_mul_u32_u24 v4, 48, v3
    v_sub_u32 v2, v2, v4
    v_lshlrev_b32 v8, 4, v4
    v_add_lshl_u32 v4, v3, s41, 2
    v_or_b32 v4, s44, v4
    v_xor_b32 v4, v4, v2
    v_lshl_add_u32 v17, v4, 4, v8
    v_and_or_b32 v5, v3, 1, s44
    v_lshlrev_b32 v5, 2, v5
    v_xor_b32 v2, v2, v5
    v_and_b32 v3, 2, v3
    v_lshrrev_b32 v3, v3, s47
    v_and_b32 v4, 3, v3
    v_xor_b32 v4, v4, v2
    v_lshl_add_u32 v11, v4, 4, v8
    v_bfe_u32 v4, v3, 4, 2
    v_xor_b32 v4, v4, v2
    v_lshl_add_u32 v4, v4, 4, v8
    v_add_u32 v14, 3072, v4
    v_add_u32 v2, 128, v0
    v_mul_u32_u24 v3, 1366, v2
    v_lshrrev_b32 v3, 16, v3
    v_mul_u32_u24 v4, 48, v3
    v_sub_u32 v2, v2, v4
    v_lshlrev_b32 v8, 4, v4
    v_and_or_b32 v5, v3, 1, s44
    v_lshlrev_b32 v5, 2, v5
    v_xor_b32 v2, v2, v5
    v_and_b32 v3, 2, v3
    v_lshrrev_b32 v3, v3, s47
    v_and_b32 v4, 3, v3
    v_xor_b32 v4, v4, v2
    v_lshl_add_u32 v12, v4, 4, v8
    v_bfe_u32 v4, v3, 4, 2
    v_xor_b32 v4, v4, v2
    v_lshl_add_u32 v4, v4, 4, v8
    v_add_u32 v15, 3072, v4
    s_mul_i32 s24, s3, 6144
    s_mul_i32 s34, s3, -4608
    s_add_u32 s34, s34, 19456
    s_add_u32 s31, s24, 153600
    v_and_b32 v2, 15, v0
    v_lshrrev_b32 v3, 4, v0
    v_lshrrev_b32 v4, 2, v2
    v_lshlrev_b32 v5, 1, v4
    v_lshrrev_b32 v89, v5, s47
    v_and_b32 v89, 3, v89
    v_and_b32 v88, 3, v2
    v_lshl_or_b32 v89, v88, 2, v89
    v_xor_b32 v89, v89, v3
    v_lshlrev_b32 v89, 4, v89
    v_lshrrev_b32 v88, 1, v88
    v_lshl_add_u32 v5, v88, 4, v5
    v_and_or_b32 v5, v2, 1, v5
    v_mul_u32_u24 v5, 768, v5
    s_mul_i32 s30, s4, 30720
    v_add3_u32 v18, v5, v89, s30
    v_and_b32 v88, 1, v0
    v_lshlrev_b32 v5, 1, v88
    v_lshl_or_b32 v5, v4, 2, v5
    v_xor_b32 v5, v5, v3
    v_lshlrev_b32 v5, 4, v5
    v_lshl_add_u32 v88, v88, 2, v4
    v_mul_u32_u24 v88, 768, v88
    s_add_u32 s30, s30, 24576
    v_add3_u32 v22, v5, v88, s30
    v_xor_b32 v19, 64, v18
    v_xor_b32 v23, 64, v22
    v_xor_b32 v20, 128, v18
    v_xor_b32 v24, 128, v22
    v_xor_b32 v21, 192, v18
    v_xor_b32 v25, 192, v22
    s_lshl_b32 s30, s5, 4
    v_add_u32 v5, s30, v2
    v_lshrrev_b32 v88, 1, v3
    v_lshlrev_b32 v88, 9, v88
    v_lshl_add_u32 v88, v5, 4, v88
    v_and_b32 v89, 1, v3
    v_lshl_add_u32 v88, v89, 3, v88
    s_lshl_b32 s30, s4, 11
    s_add_u32 s30, s30, 153600
    v_add_u32 v26, s30, v88
    v_lshlrev_b32 v88, 4, v5
    v_lshl_add_u32 v88, v3, 1, v88
    s_lshl_b32 s30, s4, 3
    s_add_u32 s30, s30, 157696
    v_add_u32 v27, s30, v88
    v_lshlrev_b32 v1, 3, v0
    v_add_u32 v28, 157696, v6
    v_lshlrev_b32 v29, 2, v5
    v_add_u32 v29, 158720, v29
    v_mov_b32 v30, 158976
    v_mov_b32 v32, 0xc1800000
    v_mov_b32 v33, 0xc1800000
    v_mov_b32 v34, 0xc1800000
    v_mov_b32 v35, 0xc1800000
    s_lshr_b32 s30, s6, 3
    s_and_b32 s30, s30, 3
    s_mov_b32 s44, 4294967058
    s_mov_b32 s46, 1
    s_mov_b32 s47, 4
    s_cmp_eq_u32 s30, 1
    s_cselect_b32 s44, 4294967108, s44
    s_cselect_b32 s46, 2, s46
    s_cselect_b32 s47, 6, s47
    s_cmp_eq_u32 s30, 2
    s_cselect_b32 s44, 4294967176, s44
    s_cselect_b32 s46, 3, s46
    s_cselect_b32 s47, 7, s47
    s_cmp_eq_u32 s30, 3
    s_cselect_b32 s44, 4294967073, s44
    s_cselect_b32 s46, 0, s46
    s_cselect_b32 s47, 5, s47
    s_mov_b64 s[28:29], -1
    s_mov_b32 s45, s4
    s_mov_b32 s25, 0
    s_mov_b32 s33, 61440
    s_mov_b32 s49, 0
    s_mul_i32 s52, s5, 24576
    s_add_u32 s52, s52, 49152
    s_add_u32 s53, s52, 4096
    s_add_u32 s54, s52, 8192
    s_add_u32 s55, s52, 12288
    s_add_u32 s56, s52, 16384
    s_add_u32 s57, s52, 20480
    s_bfe_u32 s36, s6, 0x10002
    s_mul_i32 s36, s36, 3
    s_and_b32 s30, s6, 3
    s_add_u32 s36, s36, s30
    s_sub_u32 s36, s36, 1
    s_lshr_b32 s37, s6, 3
    s_mul_i32 s38, s36, 1605632
    s_add_u32 s38, s38, 2097152
    s_lshl_b32 s39, s36, 7
    s_add_u32 s39, s39, 623616
    s_and_b32 s48, s37, 3
    s_lshl_b32 s51, s48, 7
    s_add_u32 s51, s51, 622592
    s_cmp_eq_u32 s3, 0
    s_cselect_b32 s58, 8, 64
    s_waitcnt vmcnt(0)
    s_mov_b64 exec, 0
    s_cmp_eq_u32 s3, 0
    s_cbranch_scc1 Lw_0
    s_cmp_eq_u32 s3, 1
    s_cbranch_scc1 Lw_1
    s_cmp_eq_u32 s3, 2
    s_cbranch_scc1 Lw_2
    s_branch Lw_3
Lw_ret:
    s_mov_b64 exec, -1
    s_setprio 2
    s_waitcnt lgkmcnt(0)
    s_barrier
Lw_6:
    s_cbranch_execz Lw_10
    s_lshl_b32 s60, s5, 7
    s_mov_b64 exec, 1
    buffer_load_dwordx4 v[2:5], off, s[20:23], s60 sc1
    s_mov_b64 exec, -1
    buffer_load_dwordx4 v[192:195], v6, s[8:11], s26 offen offset:0 nt
    buffer_load_dwordx4 v[196:199], v6, s[8:11], s26 offen offset:1024 nt
    buffer_load_dwordx4 v[200:203], v6, s[8:11], s26 offen offset:2048 nt
    buffer_load_dwordx4 v[204:207], v6, s[8:11], s26 offen offset:3072 nt
    buffer_load_dwordx4 v[208:211], v7, s[8:11], s26 offen offset:0 nt
    buffer_load_dwordx4 v[212:215], v7, s[8:11], s26 offen offset:1024 nt
    buffer_load_dwordx4 v[216:219], v6, s[12:15], s27 offen nt
    s_mov_b32 exec_hi, 0
    buffer_load_dwordx4 v[220:223], v6, s[12:15], s27 offen offset:1024 nt
    s_mov_b32 exec_hi, -1
    s_add_u32 s26, s26, 9437184
    s_add_u32 s27, s27, 2359296
    buffer_load_dwordx4 v[224:227], v6, s[8:11], s26 offen offset:0 nt
    buffer_load_dwordx4 v[228:231], v6, s[8:11], s26 offen offset:1024 nt
    buffer_load_dwordx4 v[232:235], v6, s[8:11], s26 offen offset:2048 nt
    buffer_load_dwordx4 v[236:239], v6, s[8:11], s26 offen offset:3072 nt
    buffer_load_dwordx4 v[240:243], v7, s[8:11], s26 offen offset:0 nt
    buffer_load_dwordx4 v[244:247], v7, s[8:11], s26 offen offset:1024 nt
    buffer_load_dwordx4 v[248:251], v6, s[12:15], s27 offen nt
    s_mov_b32 exec_hi, 0
    buffer_load_dwordx4 v[252:255], v6, s[12:15], s27 offen offset:1024 nt
    s_mov_b32 exec_hi, -1
    s_add_u32 s26, s26, 9437184
    s_add_u32 s27, s27, 2359296
    s_waitcnt vmcnt(16)
L_ew_8:
    v_readfirstlane_b32 s30, v3
    s_cmp_lg_u32 s30, 0
    s_cbranch_scc0 L_ew_8_r
L_ew_8_d:
    s_mul_i32 s30, s3, 12288
    s_add_u32 m0, s30, 92160
    s_mul_i32 s43, s4, 12288
    s_add_u32 s43, s43, s52
    buffer_load_dwordx4 v6, s[16:19], s43 offen offset:0 sc1 lds
    buffer_load_dwordx4 v6, s[16:19], s43 offen offset:1024 sc1 lds
    buffer_load_dwordx4 v6, s[16:19], s43 offen offset:2048 sc1 lds
    buffer_load_dwordx4 v6, s[16:19], s43 offen offset:3072 sc1 lds
    s_add_u32 m0, m0, 4096
    s_add_u32 s43, s43, 4096
    buffer_load_dwordx4 v6, s[16:19], s43 offen offset:0 sc1 lds
    buffer_load_dwordx4 v6, s[16:19], s43 offen offset:1024 sc1 lds
    buffer_load_dwordx4 v6, s[16:19], s43 offen offset:2048 sc1 lds
    buffer_load_dwordx4 v6, s[16:19], s43 offen offset:3072 sc1 lds
    s_add_u32 m0, m0, 4096
    s_add_u32 s43, s43, 4096
    buffer_load_dwordx4 v6, s[16:19], s43 offen offset:0 sc1 lds
    buffer_load_dwordx4 v6, s[16:19], s43 offen offset:1024 sc1 lds
    buffer_load_dwordx4 v6, s[16:19], s43 offen offset:2048 sc1 lds
    buffer_load_dwordx4 v6, s[16:19], s43 offen offset:3072 sc1 lds
    s_mul_i32 s30, s5, 24576
    s_add_u32 s30, s30, 92160
    v_add_u32 v3, s30, v6
    s_setprio 0
    s_waitcnt vmcnt(0)
    s_barrier
    s_cmp_lg_u32 s3, 0
    s_cbranch_scc1 L_nxg
    s_getreg_b32 s30, hwreg(HW_REG_XCC_ID, 0, 3)
    s_lshl_b32 s30, s30, 3
    s_lshl_b64 s[40:41], 1, s30
    v_mov_b32 v88, s40
    v_mov_b32 v89, s41
    s_mov_b64 exec, 1
    buffer_atomic_add_x2 v[88:89], off, s[16:19], s39
    s_mov_b64 exec, -1
L_nxg:
    ds_read_b128 v[96:99], v3 offset:0
    ds_read_b128 v[100:103], v3 offset:1024
    ds_read_b128 v[104:107], v3 offset:2048
    ds_read_b128 v[108:111], v3 offset:3072
    ds_read_b128 v[112:115], v3 offset:4096
    ds_read_b128 v[116:119], v3 offset:5120
    ds_read_b128 v[120:123], v3 offset:6144
    ds_read_b128 v[124:127], v3 offset:7168
    ds_read_b128 v[128:131], v3 offset:8192
    ds_read_b128 v[132:135], v3 offset:9216
    ds_read_b128 v[136:139], v3 offset:10240
    s_waitcnt lgkmcnt(10)
    v_max3_u32 v2, v96, v97, v96
    v_max3_u32 v2, v2, v98, v99
    ds_read_b128 v[140:143], v3 offset:11264
    s_waitcnt lgkmcnt(10)
    v_max3_u32 v2, v100, v101, v2
    v_max3_u32 v2, v2, v102, v103
    ds_read_b128 v[144:147], v3 offset:12288
    s_waitcnt lgkmcnt(10)
    v_max3_u32 v2, v104, v105, v2
    v_max3_u32 v2, v2, v106, v107
    ds_read_b128 v[148:151], v3 offset:13312
    s_waitcnt lgkmcnt(10)
    v_max3_u32 v2, v108, v109, v2
    v_max3_u32 v2, v2, v110, v111
    ds_read_b128 v[152:155], v3 offset:14336
    s_waitcnt lgkmcnt(10)
    v_max3_u32 v2, v112, v113, v2
    v_max3_u32 v2, v2, v114, v115
    ds_read_b128 v[156:159], v3 offset:15360
    s_waitcnt lgkmcnt(10)
Lw_7:
    s_cbranch_execz Lw_11
    v_max3_u32 v2, v116, v117, v2
    v_max3_u32 v2, v2, v118, v119
    ds_read_b128 v[160:163], v3 offset:16384
    s_waitcnt lgkmcnt(10)
    v_max3_u32 v2, v120, v121, v2
    v_max3_u32 v2, v2, v122, v123
    ds_read_b128 v[164:167], v3 offset:17408
    s_waitcnt lgkmcnt(10)
    v_max3_u32 v2, v124, v125, v2
    v_max3_u32 v2, v2, v126, v127
    ds_read_b128 v[168:171], v3 offset:18432
    s_waitcnt lgkmcnt(10)
    v_max3_u32 v2, v128, v129, v2
    v_max3_u32 v2, v2, v130, v131
    ds_read_b128 v[172:175], v3 offset:19456
    s_waitcnt lgkmcnt(10)
    v_max3_u32 v2, v132, v133, v2
    v_max3_u32 v2, v2, v134, v135
    ds_read_b128 v[176:179], v3 offset:20480
    s_waitcnt lgkmcnt(10)
    v_max3_u32 v2, v136, v137, v2
    v_max3_u32 v2, v2, v138, v139
    ds_read_b128 v[180:183], v3 offset:21504
    s_waitcnt lgkmcnt(10)
    v_max3_u32 v2, v140, v141, v2
    v_max3_u32 v2, v2, v142, v143
    ds_read_b128 v[184:187], v3 offset:22528
    s_waitcnt lgkmcnt(10)
    v_max3_u32 v2, v144, v145, v2
    v_max3_u32 v2, v2, v146, v147
    ds_read_b128 v[188:191], v3 offset:23552
    s_waitcnt lgkmcnt(10)
    v_max3_u32 v2, v148, v149, v2
    v_max3_u32 v2, v2, v150, v151
    s_waitcnt lgkmcnt(9)
    v_max3_u32 v2, v152, v153, v2
    v_max3_u32 v2, v2, v154, v155
    s_waitcnt lgkmcnt(8)
    v_max3_u32 v2, v156, v157, v2
    v_max3_u32 v2, v2, v158, v159
    s_waitcnt lgkmcnt(7)
    v_max3_u32 v2, v160, v161, v2
    v_max3_u32 v2, v2, v162, v163
    s_waitcnt lgkmcnt(6)
    v_max3_u32 v2, v164, v165, v2
    v_max3_u32 v2, v2, v166, v167
    s_waitcnt lgkmcnt(5)
    v_max3_u32 v2, v168, v169, v2
    v_max3_u32 v2, v2, v170, v171
    s_waitcnt lgkmcnt(4)
    v_max3_u32 v2, v172, v173, v2
    v_max3_u32 v2, v2, v174, v175
    s_waitcnt lgkmcnt(3)
    v_max3_u32 v2, v176, v177, v2
    v_max3_u32 v2, v2, v178, v179
    s_waitcnt lgkmcnt(2)
    v_max3_u32 v2, v180, v181, v2
    v_max3_u32 v2, v2, v182, v183
    s_waitcnt lgkmcnt(1)
    v_max3_u32 v2, v184, v185, v2
    v_max3_u32 v2, v2, v186, v187
    s_waitcnt lgkmcnt(0)
    v_max3_u32 v2, v188, v189, v2
    v_max3_u32 v2, v2, v190, v191
    v_cmp_eq_u32 vcc, -1, v2
    s_cbranch_vccnz L_aretry
L_aok:
.p2align 3
L_s:
    s_barrier
    ds_read_b128 v[56:59], v22 offset:0
    ds_read_b128 v[60:63], v23 offset:0
    ds_read_b128 v[64:67], v24 offset:0
    ds_read_b128 v[68:71], v25 offset:0
    ds_read_b128 v[72:75], v22 offset:256
    ds_read_b128 v[76:79], v23 offset:256
    ds_read_b128 v[80:83], v24 offset:256
    ds_read_b128 v[84:87], v25 offset:256
    ds_read_b32 v31, v30
    s_waitcnt lgkmcnt(7)
    v_mfma_f32_16x16x32_bf16 v[36:39], v[56:59], v[144:147], v[32:35]
    ds_read_b128 v[56:59], v22 offset:512
    v_mfma_f32_16x16x32_bf16 v[36:39], v[60:63], v[148:151], v[36:39]
    ds_read_b128 v[60:63], v23 offset:512
    s_waitcnt lgkmcnt(7)
    v_mfma_f32_16x16x32_bf16 v[36:39], v[64:67], v[152:155], v[36:39]
    ds_read_b128 v[64:67], v24 offset:512
    v_mfma_f32_16x16x32_bf16 v[36:39], v[68:71], v[156:159], v[36:39]
    ds_read_b128 v[68:71], v25 offset:512
    s_waitcnt lgkmcnt(7)
    v_mfma_f32_16x16x32_bf16 v[36:39], v[72:75], v[160:163], v[36:39]
    ds_read_b128 v[72:75], v18 offset:0
    v_mfma_f32_16x16x32_bf16 v[36:39], v[76:79], v[164:167], v[36:39]
    ds_read_b128 v[76:79], v19 offset:0
    s_waitcnt lgkmcnt(7)
    v_mfma_f32_16x16x32_bf16 v[36:39], v[80:83], v[168:171], v[36:39]
    ds_read_b128 v[80:83], v20 offset:0
    v_mfma_f32_16x16x32_bf16 v[36:39], v[84:87], v[172:175], v[36:39]
    ds_read_b128 v[84:87], v21 offset:0
    s_waitcnt lgkmcnt(6)
    v_mfma_f32_16x16x32_bf16 v[36:39], v[56:59], v[176:179], v[36:39]
    ds_read_b128 v[56:59], v18 offset:256
    v_mfma_f32_16x16x32_bf16 v[36:39], v[60:63], v[180:183], v[36:39]
Lw_8:
    s_cbranch_execz Lw_12
    ds_read_b128 v[60:63], v19 offset:256
    s_add_u32 s45, s45, 2
    s_waitcnt lgkmcnt(6)
    v_mfma_f32_16x16x32_bf16 v[36:39], v[64:67], v[184:187], v[36:39]
    ds_read_b128 v[64:67], v20 offset:256
    v_mfma_f32_16x16x32_bf16 v[36:39], v[68:71], v[188:191], v[36:39]
    ds_read_b128 v[68:71], v21 offset:256
    s_cmp_ge_u32 s45, 5
    s_cselect_b32 s32, -92160, s33
    s_cselect_b32 s30, 5, 0
    s_waitcnt lgkmcnt(6)
    v_mfma_f32_16x16x32_bf16 v[40:43], v[72:75], v[96:99], 0
    ds_read_b128 v[72:75], v18 offset:512
    s_sub_u32 s45, s45, s30
    v_mfma_f32_16x16x32_bf16 v[40:43], v[76:79], v[100:103], v[40:43]
    ds_read_b128 v[76:79], v19 offset:512
    v_add_u32 v22, s32, v22
    s_waitcnt lgkmcnt(6)
    v_mfma_f32_16x16x32_bf16 v[40:43], v[80:83], v[104:107], v[40:43]
    ds_read_b128 v[80:83], v20 offset:512
    v_mfma_f32_16x16x32_bf16 v[40:43], v[84:87], v[108:111], v[40:43]
    ds_read_b128 v[84:87], v21 offset:512
    v_add_u32 v23, s32, v23
    s_waitcnt lgkmcnt(6)
    v_mfma_f32_16x16x32_bf16 v[40:43], v[56:59], v[112:115], v[40:43]
    ds_read_b128 v[56:59], v18 offset:6144
    v_mov_b32 v44, v37
    v_mfma_f32_16x16x32_bf16 v[40:43], v[60:63], v[116:119], v[40:43]
    ds_read_b128 v[60:63], v19 offset:6144
    v_add_u32 v24, s32, v24
    s_waitcnt lgkmcnt(6)
    v_mfma_f32_16x16x32_bf16 v[40:43], v[64:67], v[120:123], v[40:43]
    ds_read_b128 v[64:67], v20 offset:6144
    v_mov_b32 v45, v37
    v_mfma_f32_16x16x32_bf16 v[40:43], v[68:71], v[124:127], v[40:43]
    ds_read_b128 v[68:71], v21 offset:6144
    v_add_u32 v25, s32, v25
    s_waitcnt lgkmcnt(6)
    v_mfma_f32_16x16x32_bf16 v[40:43], v[72:75], v[128:131], v[40:43]
    ds_read_b128 v[72:75], v18 offset:6400
    v_mov_b32 v46, v37
    v_mfma_f32_16x16x32_bf16 v[40:43], v[76:79], v[132:135], v[40:43]
    ds_read_b128 v[76:79], v19 offset:6400
    s_waitcnt lgkmcnt(6)
    v_mfma_f32_16x16x32_bf16 v[40:43], v[80:83], v[136:139], v[40:43]
    ds_read_b128 v[80:83], v20 offset:6400
    v_mov_b32 v47, v37
    v_mfma_f32_16x16x32_bf16 v[40:43], v[84:87], v[140:143], v[40:43]
    ds_read_b128 v[84:87], v21 offset:6400
    s_waitcnt lgkmcnt(6)
    v_mfma_f32_16x16x32_bf16 v[44:47], v[56:59], v[96:99], v[44:47]
    ds_read_b128 v[56:59], v18 offset:6656
    v_mfma_f32_16x16x32_bf16 v[44:47], v[60:63], v[100:103], v[44:47]
    ds_read_b128 v[60:63], v19 offset:6656
    s_waitcnt lgkmcnt(6)
    v_mfma_f32_16x16x32_bf16 v[44:47], v[64:67], v[104:107], v[44:47]
    ds_read_b128 v[64:67], v20 offset:6656
    v_mfma_f32_16x16x32_bf16 v[44:47], v[68:71], v[108:111], v[44:47]
    ds_read_b128 v[68:71], v21 offset:6656
    v_add_f32 v40, v40, v36
    s_waitcnt lgkmcnt(6)
    v_mfma_f32_16x16x32_bf16 v[44:47], v[72:75], v[112:115], v[44:47]
    v_add_f32 v41, v41, v36
    v_add_f32 v42, v42, v36
    v_add_f32 v43, v43, v36
    v_mfma_f32_16x16x32_bf16 v[44:47], v[76:79], v[116:119], v[44:47]
    v_exp_f32 v88, v40
    v_exp_f32 v89, v41
    s_waitcnt lgkmcnt(4)
    v_mfma_f32_16x16x32_bf16 v[44:47], v[80:83], v[120:123], v[44:47]
    v_exp_f32 v90, v42
    v_exp_f32 v91, v43
    v_mfma_f32_16x16x32_bf16 v[44:47], v[84:87], v[124:127], v[44:47]
    v_add_f32 v92, v88, v89
    v_add_f32 v93, v90, v91
    s_waitcnt lgkmcnt(2)
    v_mfma_f32_16x16x32_bf16 v[44:47], v[56:59], v[128:131], v[44:47]
    v_cvt_pk_bf16_f32 v52, v88, v89
    v_cvt_pk_bf16_f32 v53, v90, v91
    v_mfma_f32_16x16x32_bf16 v[44:47], v[60:63], v[132:135], v[44:47]
    v_add_f32 v92, v92, v93
    ds_write_b64 v26, v[52:53] offset:0
    s_waitcnt lgkmcnt(1)
    v_mfma_f32_16x16x32_bf16 v[44:47], v[64:67], v[136:139], v[44:47]
    v_cvt_pk_bf16_f32 v54, v92, v92
    ds_write_b16 v27, v54 offset:0
    v_mfma_f32_16x16x32_bf16 v[44:47], v[68:71], v[140:143], v[44:47]
    v_add_u32 v18, s32, v18
    v_add_u32 v19, s32, v19
    v_add_u32 v20, s32, v20
    v_add_u32 v21, s32, v21
    s_nop 3
    v_exp_f32 v88, v44
    v_exp_f32 v89, v45
    v_exp_f32 v90, v46
    v_exp_f32 v91, v47
    v_add_f32 v92, v88, v89
    v_add_f32 v93, v90, v91
    v_cvt_pk_bf16_f32 v52, v88, v89
    v_cvt_pk_bf16_f32 v53, v90, v91
Lw_9:
    s_cbranch_execz Lw_13
    v_add_f32 v92, v92, v93
    ds_write_b64 v26, v[52:53] offset:1024
    v_cvt_pk_bf16_f32 v54, v92, v92
    ds_write_b16 v27, v54 offset:512
    s_waitcnt lgkmcnt(0)
    s_barrier
    ds_read_b128 v[48:51], v28
    s_waitcnt lgkmcnt(0)
    v_or3_b32 v88, v48, v49, v50
    v_or_b32 v88, v88, v51
    v_and_b32 v88, 0x40004000, v88
    v_cmp_ne_u32 vcc, 0, v88
    s_or_b64 vcc, vcc, s[28:29]
    s_cbranch_scc1 L_s_slow
L_s_back:
    s_bitcmp1_b32 s44, s25
    s_cbranch_scc1 L_s_hook
L_s_dma:
    s_mov_b32 m0, s24
    s_nop 0
    buffer_load_dwordx4 v10, s[8:11], s26 offen nt lds
    s_add_u32 m0, m0, 1024
    s_nop 0
    buffer_load_dwordx4 v11, s[8:11], s26 offen nt lds
    s_add_u32 m0, m0, 1024
    s_nop 0
    buffer_load_dwordx4 v12, s[8:11], s26 offen nt lds
    s_add_u32 m0, m0, 1024
    s_nop 0
    buffer_load_dwordx4 v13, s[8:11], s26 offen nt lds
    s_add_u32 m0, m0, 1024
    s_nop 0
    buffer_load_dwordx4 v14, s[8:11], s26 offen nt lds
    s_add_u32 m0, m0, 1024
    s_nop 0
    buffer_load_dwordx4 v15, s[8:11], s26 offen nt lds
    s_add_u32 m0, m0, s34
    s_nop 0
    buffer_load_dwordx4 v16, s[12:15], s27 offen nt lds
    s_add_u32 m0, m0, 1024
    s_mov_b32 exec_hi, 0
    buffer_load_dwordx4 v17, s[12:15], s27 offen nt lds
    s_mov_b32 exec_hi, -1
    s_add_u32 s26, s26, 9437184
    s_add_u32 s27, s27, 2359296
    s_waitcnt vmcnt(8)
L_s_next:
    s_add_u32 s24, s24, 61440
    s_cmp_ge_u32 s24, s31
    s_cselect_b32 s30, 153600, 0
    s_sub_u32 s24, s24, s30
    s_cmp_ge_u32 s25, s58
    s_cbranch_scc1 L_s_post
L_s_postb:
    s_add_u32 s25, s25, 1
    s_min_u32 s25, s25, 31
    s_branch L_s
L_s_last:
    s_barrier
    s_mov_b32 s44, -1
    s_cmp_eq_u32 s3, 3
    s_cbranch_scc1 L_t1l
    s_branch L_t1
L_t1b:
    s_andn2_b32 s44, s44, s46
    v_lshrrev_b32 v221, v216, s46
    v_and_b32 v220, 1, v221
    v_cmp_ne_u32 vcc, 0, v220
    s_add_u32 s30, s27, 0
    s_nop 0
    v_cndmask_b32 v220, v213, v212, vcc
    buffer_load_dwordx4 v[96:99], v220, s[16:19], s30 offen sc1
    v_and_b32 v220, 4, v221
    v_cmp_ne_u32 vcc, 0, v220
    s_add_u32 s30, s27, 100352
    s_nop 0
    v_cndmask_b32 v220, v213, v212, vcc
    buffer_load_dwordx4 v[100:103], v220, s[16:19], s30 offen sc1
    v_and_b32 v220, 16, v221
    v_cmp_ne_u32 vcc, 0, v220
    s_add_u32 s30, s27, 200704
    s_nop 0
    v_cndmask_b32 v220, v213, v212, vcc
    buffer_load_dwordx4 v[104:107], v220, s[16:19], s30 offen sc1
    v_and_b32 v220, 64, v221
    v_cmp_ne_u32 vcc, 0, v220
    s_add_u32 s30, s27, 301056
    s_nop 0
    v_cndmask_b32 v220, v213, v212, vcc
    buffer_load_dwordx4 v[108:111], v220, s[16:19], s30 offen sc1
    v_and_b32 v220, 256, v221
    v_cmp_ne_u32 vcc, 0, v220
    s_add_u32 s30, s27, 401408
    s_nop 0
    v_cndmask_b32 v220, v213, v212, vcc
    buffer_load_dwordx4 v[112:115], v220, s[16:19], s30 offen sc1
    v_and_b32 v220, 1024, v221
    v_cmp_ne_u32 vcc, 0, v220
    s_add_u32 s30, s27, 501760
    s_nop 0
    v_cndmask_b32 v220, v213, v212, vcc
    buffer_load_dwordx4 v[116:119], v220, s[16:19], s30 offen sc1
    v_and_b32 v220, 4096, v221
    v_cmp_ne_u32 vcc, 0, v220
    s_add_u32 s30, s27, 602112
    s_nop 0
Lw_10:
    s_cbranch_execz Lw_14
    v_cndmask_b32 v220, v213, v212, vcc
    buffer_load_dwordx4 v[120:123], v220, s[16:19], s30 offen sc1
    v_and_b32 v220, 16384, v221
    v_cmp_ne_u32 vcc, 0, v220
    s_add_u32 s30, s27, 702464
    s_nop 0
    v_cndmask_b32 v220, v213, v212, vcc
    buffer_load_dwordx4 v[124:127], v220, s[16:19], s30 offen sc1
    v_and_b32 v220, 65536, v221
    v_cmp_ne_u32 vcc, 0, v220
    s_add_u32 s30, s27, 802816
    s_nop 0
    v_cndmask_b32 v220, v213, v212, vcc
    buffer_load_dwordx4 v[128:131], v220, s[16:19], s30 offen sc1
    v_and_b32 v220, 262144, v221
    v_cmp_ne_u32 vcc, 0, v220
    s_add_u32 s30, s27, 903168
    s_nop 0
    v_cndmask_b32 v220, v213, v212, vcc
    buffer_load_dwordx4 v[132:135], v220, s[16:19], s30 offen sc1
    v_and_b32 v220, 1048576, v221
    v_cmp_ne_u32 vcc, 0, v220
    s_add_u32 s30, s27, 1003520
    s_nop 0
    v_cndmask_b32 v220, v213, v212, vcc
    buffer_load_dwordx4 v[136:139], v220, s[16:19], s30 offen sc1
    v_and_b32 v220, 4194304, v221
    v_cmp_ne_u32 vcc, 0, v220
    s_add_u32 s30, s27, 1103872
    s_nop 0
    v_cndmask_b32 v220, v213, v212, vcc
    buffer_load_dwordx4 v[140:143], v220, s[16:19], s30 offen sc1
    v_and_b32 v220, 16777216, v221
    v_cmp_ne_u32 vcc, 0, v220
    s_add_u32 s30, s27, 1204224
    s_nop 0
    v_cndmask_b32 v220, v213, v212, vcc
    buffer_load_dwordx4 v[144:147], v220, s[16:19], s30 offen sc1
    v_and_b32 v220, 67108864, v221
    v_cmp_ne_u32 vcc, 0, v220
    s_add_u32 s30, s27, 1304576
    s_nop 0
    v_cndmask_b32 v220, v213, v212, vcc
    buffer_load_dwordx4 v[148:151], v220, s[16:19], s30 offen sc1
    v_and_b32 v220, 268435456, v221
    v_cmp_ne_u32 vcc, 0, v220
    s_add_u32 s30, s27, 1404928
    s_nop 0
    v_cndmask_b32 v220, v213, v212, vcc
    buffer_load_dwordx4 v[152:155], v220, s[16:19], s30 offen sc1
    v_and_b32 v220, 1073741824, v221
    v_cmp_ne_u32 vcc, 0, v220
    s_add_u32 s30, s27, 1505280
    s_nop 0
    v_cndmask_b32 v220, v213, v212, vcc
    buffer_load_dwordx4 v[156:159], v220, s[16:19], s30 offen sc1
    s_waitcnt vmcnt(15)
    v_mfma_f32_32x32x16_bf16 v[196:211], v[192:195], v[96:99], v[196:211]
    s_waitcnt vmcnt(14)
    v_mfma_f32_32x32x16_bf16 v[196:211], v[192:195], v[100:103], v[196:211]
    s_waitcnt vmcnt(13)
    v_mfma_f32_32x32x16_bf16 v[196:211], v[192:195], v[104:107], v[196:211]
    s_waitcnt vmcnt(12)
    v_mfma_f32_32x32x16_bf16 v[196:211], v[192:195], v[108:111], v[196:211]
    s_waitcnt vmcnt(11)
    v_mfma_f32_32x32x16_bf16 v[196:211], v[192:195], v[112:115], v[196:211]
    s_waitcnt vmcnt(10)
    v_mfma_f32_32x32x16_bf16 v[196:211], v[192:195], v[116:119], v[196:211]
    s_waitcnt vmcnt(9)
    v_mfma_f32_32x32x16_bf16 v[196:211], v[192:195], v[120:123], v[196:211]
    s_mov_b32 exec_hi, 0
    buffer_load_dword v214, v215, s[16:19], s40 offen sc1
    s_mov_b32 exec_hi, -1
    s_waitcnt vmcnt(9)
    v_mfma_f32_32x32x16_bf16 v[196:211], v[192:195], v[124:127], v[196:211]
    s_waitcnt vmcnt(8)
    v_mfma_f32_32x32x16_bf16 v[196:211], v[192:195], v[128:131], v[196:211]
    s_waitcnt vmcnt(7)
    v_mfma_f32_32x32x16_bf16 v[196:211], v[192:195], v[132:135], v[196:211]
    s_waitcnt vmcnt(6)
    v_mfma_f32_32x32x16_bf16 v[196:211], v[192:195], v[136:139], v[196:211]
    s_waitcnt vmcnt(5)
    v_mfma_f32_32x32x16_bf16 v[196:211], v[192:195], v[140:143], v[196:211]
    s_waitcnt vmcnt(4)
    v_mfma_f32_32x32x16_bf16 v[196:211], v[192:195], v[144:147], v[196:211]
    s_waitcnt vmcnt(3)
    v_mfma_f32_32x32x16_bf16 v[196:211], v[192:195], v[148:151], v[196:211]
    s_waitcnt vmcnt(2)
    v_mfma_f32_32x32x16_bf16 v[196:211], v[192:195], v[152:155], v[196:211]
    s_waitcnt vmcnt(1)
    v_mfma_f32_32x32x16_bf16 v[196:211], v[192:195], v[156:159], v[196:211]
    s_cmp_eq_u32 s44, 0
    s_cbranch_scc1 L_t1done
    s_branch L_t1w
L_t1s:
L_t1:
    s_mov_b32 exec_hi, 0
    buffer_load_dword v214, v215, s[16:19], s40 offen sc1
    s_mov_b32 exec_hi, -1
    s_sub_u32 s61, s61, 1
    s_cmp_gt_i32 s61, 0
    s_cbranch_scc0 L_t1done
L_t1w:
Lw_11:
    s_cbranch_execz Lw_15
    s_waitcnt vmcnt(0)
    v_cmp_ne_u32 vcc, -1, v214
    s_and_b32 s46, vcc_lo, s44
    s_cbranch_scc0 L_t1s
    s_bcnt1_i32_b32 s30, s46
    s_cmp_gt_u32 s30, 16
    s_cbranch_scc1 L_t1b
    s_andn2_b32 s44, s44, s46
    s_ff1_i32_b32 s48, s46
    s_bitset0_b32 s46, s48
    s_ff1_i32_b32 s30, s46
    s_lshl_b32 s47, s30, 8
    s_or_b32 s48, s48, s47
    s_lshl_b64 s[56:57], 1, s30
    s_andn2_b32 s46, s46, s56
    v_bfe_u32 v220, s48, v217, 8
    v_cmp_gt_u32 vcc, 32, v220
    v_mad_u32_u24 v220, v220, s43, v218
    s_cmp_eq_u32 s46, 0
    v_cndmask_b32 v220, v213, v220, vcc
    buffer_load_dwordx4 v[96:99], v220, s[16:19], s27 offen sc1
    s_cbranch_scc1 L_t1m0
    s_ff1_i32_b32 s48, s46
    s_bitset0_b32 s46, s48
    s_ff1_i32_b32 s30, s46
    s_lshl_b32 s47, s30, 8
    s_or_b32 s48, s48, s47
    s_lshl_b64 s[56:57], 1, s30
    s_andn2_b32 s46, s46, s56
    v_bfe_u32 v220, s48, v217, 8
    v_cmp_gt_u32 vcc, 32, v220
    v_mad_u32_u24 v220, v220, s43, v218
    s_cmp_eq_u32 s46, 0
    v_cndmask_b32 v220, v213, v220, vcc
    buffer_load_dwordx4 v[100:103], v220, s[16:19], s27 offen sc1
    s_cbranch_scc1 L_t1m1
    s_ff1_i32_b32 s48, s46
    s_bitset0_b32 s46, s48
    s_ff1_i32_b32 s30, s46
    s_lshl_b32 s47, s30, 8
    s_or_b32 s48, s48, s47
    s_lshl_b64 s[56:57], 1, s30
    s_andn2_b32 s46, s46, s56
    v_bfe_u32 v220, s48, v217, 8
    v_cmp_gt_u32 vcc, 32, v220
    v_mad_u32_u24 v220, v220, s43, v218
    s_cmp_eq_u32 s46, 0
    v_cndmask_b32 v220, v213, v220, vcc
    buffer_load_dwordx4 v[104:107], v220, s[16:19], s27 offen sc1
    s_cbranch_scc1 L_t1m2
    s_ff1_i32_b32 s48, s46
    s_bitset0_b32 s46, s48
    s_ff1_i32_b32 s30, s46
    s_lshl_b32 s47, s30, 8
    s_or_b32 s48, s48, s47
    s_lshl_b64 s[56:57], 1, s30
    s_andn2_b32 s46, s46, s56
    v_bfe_u32 v220, s48, v217, 8
    v_cmp_gt_u32 vcc, 32, v220
    v_mad_u32_u24 v220, v220, s43, v218
    s_cmp_eq_u32 s46, 0
    v_cndmask_b32 v220, v213, v220, vcc
    buffer_load_dwordx4 v[108:111], v220, s[16:19], s27 offen sc1
    s_cbranch_scc1 L_t1m3
    s_ff1_i32_b32 s48, s46
    s_bitset0_b32 s46, s48
    s_ff1_i32_b32 s30, s46
    s_lshl_b32 s47, s30, 8
    s_or_b32 s48, s48, s47
    s_lshl_b64 s[56:57], 1, s30
    s_andn2_b32 s46, s46, s56
    v_bfe_u32 v220, s48, v217, 8
    v_cmp_gt_u32 vcc, 32, v220
    v_mad_u32_u24 v220, v220, s43, v218
    s_cmp_eq_u32 s46, 0
    v_cndmask_b32 v220, v213, v220, vcc
    buffer_load_dwordx4 v[112:115], v220, s[16:19], s27 offen sc1
    s_cbranch_scc1 L_t1m4
    s_ff1_i32_b32 s48, s46
    s_bitset0_b32 s46, s48
    s_ff1_i32_b32 s30, s46
    s_lshl_b32 s47, s30, 8
    s_or_b32 s48, s48, s47
    s_lshl_b64 s[56:57], 1, s30
    s_andn2_b32 s46, s46, s56
    v_bfe_u32 v220, s48, v217, 8
    v_cmp_gt_u32 vcc, 32, v220
    v_mad_u32_u24 v220, v220, s43, v218
    s_cmp_eq_u32 s46, 0
    v_cndmask_b32 v220, v213, v220, vcc
    buffer_load_dwordx4 v[116:119], v220, s[16:19], s27 offen sc1
    s_cbranch_scc1 L_t1m5
    s_ff1_i32_b32 s48, s46
    s_bitset0_b32 s46, s48
    s_ff1_i32_b32 s30, s46
    s_lshl_b32 s47, s30, 8
    s_or_b32 s48, s48, s47
    s_lshl_b64 s[56:57], 1, s30
    s_andn2_b32 s46, s46, s56
    v_bfe_u32 v220, s48, v217, 8
Lw_12:
    s_cbranch_execz Lw_16
    v_cmp_gt_u32 vcc, 32, v220
    v_mad_u32_u24 v220, v220, s43, v218
    s_cmp_eq_u32 s46, 0
    v_cndmask_b32 v220, v213, v220, vcc
    buffer_load_dwordx4 v[120:123], v220, s[16:19], s27 offen sc1
    s_cbranch_scc1 L_t1m6
    s_ff1_i32_b32 s48, s46
    s_bitset0_b32 s46, s48
    s_ff1_i32_b32 s30, s46
    s_lshl_b32 s47, s30, 8
    s_or_b32 s48, s48, s47
    s_lshl_b64 s[56:57], 1, s30
    s_andn2_b32 s46, s46, s56
    v_bfe_u32 v220, s48, v217, 8
    v_cmp_gt_u32 vcc, 32, v220
    v_mad_u32_u24 v220, v220, s43, v218
    s_cmp_eq_u32 s46, 0
    v_cndmask_b32 v220, v213, v220, vcc
    buffer_load_dwordx4 v[124:127], v220, s[16:19], s27 offen sc1
    s_mov_b32 exec_hi, 0
    buffer_load_dword v214, v215, s[16:19], s40 offen sc1
    s_mov_b32 exec_hi, -1
    s_waitcnt vmcnt(1)
L_t1n7:
    v_mfma_f32_32x32x16_bf16 v[196:211], v[192:195], v[124:127], v[196:211]
L_t1n6:
    v_mfma_f32_32x32x16_bf16 v[196:211], v[192:195], v[120:123], v[196:211]
L_t1n5:
    v_mfma_f32_32x32x16_bf16 v[196:211], v[192:195], v[116:119], v[196:211]
L_t1n4:
    v_mfma_f32_32x32x16_bf16 v[196:211], v[192:195], v[112:115], v[196:211]
L_t1n3:
    v_mfma_f32_32x32x16_bf16 v[196:211], v[192:195], v[108:111], v[196:211]
L_t1n2:
    v_mfma_f32_32x32x16_bf16 v[196:211], v[192:195], v[104:107], v[196:211]
L_t1n1:
    v_mfma_f32_32x32x16_bf16 v[196:211], v[192:195], v[100:103], v[196:211]
L_t1n0:
    v_mfma_f32_32x32x16_bf16 v[196:211], v[192:195], v[96:99], v[196:211]
    s_cmp_lg_u32 s44, 0
    s_cbranch_scc1 L_t1w
L_t1done:
    v_readfirstlane_b32 s47, v214
    s_nop 1
    v_cmp_ne_u32 vcc, s47, v214
    s_cmp_eq_u32 s47, -2
    s_cselect_b32 s30, 1, 0
    s_or_b32 s30, s30, vcc_lo
    s_cbranch_scc1 L_t1gen
    s_nop 2
L_t1back:
    v_cvt_pk_bf16_f32 v196, v196, v197
    v_cvt_pk_bf16_f32 v197, v198, v199
    v_cvt_pk_bf16_f32 v198, v200, v201
    v_cvt_pk_bf16_f32 v199, v202, v203
    v_min_u32 v196, -2, v196
    v_min_u32 v197, -2, v197
    v_min_u32 v198, -2, v198
    v_min_u32 v199, -2, v199
    s_mov_b32 exec_hi, 0
    buffer_store_dwordx4 v[196:199], v222, s[16:19], s26 offen sc1
L_fin:
L_end:
    s_endpgm
L_t1m6:
    s_mov_b32 exec_hi, 0
    buffer_load_dword v214, v215, s[16:19], s40 offen sc1
    s_mov_b32 exec_hi, -1
    s_waitcnt vmcnt(1)
    s_branch L_t1n6
L_t1m5:
    s_mov_b32 exec_hi, 0
    buffer_load_dword v214, v215, s[16:19], s40 offen sc1
    s_mov_b32 exec_hi, -1
    s_waitcnt vmcnt(1)
    s_branch L_t1n5
L_t1m4:
    s_mov_b32 exec_hi, 0
    buffer_load_dword v214, v215, s[16:19], s40 offen sc1
    s_mov_b32 exec_hi, -1
    s_waitcnt vmcnt(1)
    s_branch L_t1n4
L_t1m3:
    s_mov_b32 exec_hi, 0
    buffer_load_dword v214, v215, s[16:19], s40 offen sc1
    s_mov_b32 exec_hi, -1
    s_waitcnt vmcnt(1)
    s_branch L_t1n3
L_t1m2:
    s_mov_b32 exec_hi, 0
    buffer_load_dword v214, v215, s[16:19], s40 offen sc1
    s_mov_b32 exec_hi, -1
    s_waitcnt vmcnt(1)
    s_branch L_t1n2
L_t1m1:
    s_mov_b32 exec_hi, 0
    buffer_load_dword v214, v215, s[16:19], s40 offen sc1
    s_mov_b32 exec_hi, -1
    s_waitcnt vmcnt(1)
    s_branch L_t1n1
L_t1m0:
    s_mov_b32 exec_hi, 0
    buffer_load_dword v214, v215, s[16:19], s40 offen sc1
    s_mov_b32 exec_hi, -1
    s_waitcnt vmcnt(1)
    s_branch L_t1n0
L_t1l:
    s_cmp_lg_u32 s37, 0
    s_cbranch_scc1 L_fin
    v_bfe_u32 v2, v0, 4, 1
    v_mul_u32_u24 v2, 640, v2
    v_add_u32 v2, v2, v1
    s_lshl_b32 s26, s36, 7
    s_add_u32 s26, s26, 573440
L_t1lw:
    s_mov_b32 exec_hi, 0
    buffer_load_dword v214, v215, s[16:19], s40 offen sc1
    s_mov_b32 exec_hi, -1
    s_waitcnt vmcnt(0)
    v_cmp_eq_u32 vcc, -1, v214
    s_cmp_eq_u32 vcc_lo, 0
Lw_13:
    s_cbranch_execz Lw_17
    s_cbranch_scc1 L_t1ld
    s_sub_u32 s61, s61, 1
    s_cmp_gt_i32 s61, 0
    s_cbranch_scc1 L_t1lw
L_t1ld:
    s_add_u32 s30, s41, 0
    buffer_load_dwordx2 v[160:161], v219, s[16:19], s30 offen sc1
    s_add_u32 s30, s41, 100352
    buffer_load_dwordx2 v[162:163], v219, s[16:19], s30 offen sc1
    s_add_u32 s30, s41, 200704
    buffer_load_dwordx2 v[164:165], v219, s[16:19], s30 offen sc1
    s_add_u32 s30, s41, 301056
    buffer_load_dwordx2 v[166:167], v219, s[16:19], s30 offen sc1
    s_add_u32 s30, s41, 401408
    buffer_load_dwordx2 v[168:169], v219, s[16:19], s30 offen sc1
    s_add_u32 s30, s41, 501760
    buffer_load_dwordx2 v[170:171], v219, s[16:19], s30 offen sc1
    s_add_u32 s30, s41, 602112
    buffer_load_dwordx2 v[172:173], v219, s[16:19], s30 offen sc1
    s_add_u32 s30, s41, 702464
    buffer_load_dwordx2 v[174:175], v219, s[16:19], s30 offen sc1
    s_add_u32 s30, s41, 802816
    buffer_load_dwordx2 v[176:177], v219, s[16:19], s30 offen sc1
    s_add_u32 s30, s41, 903168
    buffer_load_dwordx2 v[178:179], v219, s[16:19], s30 offen sc1
    s_add_u32 s30, s41, 1003520
    buffer_load_dwordx2 v[180:181], v219, s[16:19], s30 offen sc1
    s_add_u32 s30, s41, 1103872
    buffer_load_dwordx2 v[182:183], v219, s[16:19], s30 offen sc1
    s_add_u32 s30, s41, 1204224
    buffer_load_dwordx2 v[184:185], v219, s[16:19], s30 offen sc1
    s_add_u32 s30, s41, 1304576
    buffer_load_dwordx2 v[186:187], v219, s[16:19], s30 offen sc1
    s_add_u32 s30, s41, 1404928
    buffer_load_dwordx2 v[188:189], v219, s[16:19], s30 offen sc1
    s_add_u32 s30, s41, 1505280
    buffer_load_dwordx2 v[190:191], v219, s[16:19], s30 offen sc1
    v_readfirstlane_b32 s47, v214
    s_nop 1
    v_cmp_ne_u32 vcc, s47, v214
    s_cmp_eq_u32 s47, -2
    s_cselect_b32 s30, 1, 0
    s_or_b32 s30, s30, vcc_lo
    s_cbranch_scc1 L_t1lg
    v_mov_b32 v220, s47
    s_waitcnt vmcnt(14)
    v_add_f32 v221, v161, v163
    s_waitcnt vmcnt(13)
    v_add_f32 v221, v221, v165
    s_waitcnt vmcnt(12)
    v_add_f32 v221, v221, v167
    s_waitcnt vmcnt(11)
    v_add_f32 v221, v221, v169
    s_waitcnt vmcnt(10)
    v_add_f32 v221, v221, v171
    s_waitcnt vmcnt(9)
    v_add_f32 v221, v221, v173
    s_waitcnt vmcnt(8)
    v_add_f32 v221, v221, v175
    s_waitcnt vmcnt(7)
    v_add_f32 v221, v221, v177
    s_waitcnt vmcnt(6)
    v_add_f32 v221, v221, v179
    s_waitcnt vmcnt(5)
    v_add_f32 v221, v221, v181
    s_waitcnt vmcnt(4)
    v_add_f32 v221, v221, v183
    s_waitcnt vmcnt(3)
    v_add_f32 v221, v221, v185
    s_waitcnt vmcnt(2)
    v_add_f32 v221, v221, v187
    s_waitcnt vmcnt(1)
    v_add_f32 v221, v221, v189
    s_waitcnt vmcnt(0)
    v_add_f32 v221, v221, v191
L_t1lb:
    v_mov_b32 v3, v221
    v_min_u32 v220, -2, v220
    s_nop 0
    v_permlane32_swap_b32 v221, v3
    v_add_f32 v221, v221, v3
    v_min_u32 v221, -2, v221
    s_mov_b32 exec_hi, 0
    buffer_store_dwordx2 v[220:221], v2, s[16:19], s26 offen sc1
    s_branch L_fin
L_t1lg:
    s_waitcnt vmcnt(0)
    v_max_f32 v220, v160, v162
    v_max3_f32 v220, v220, v164, v166
    v_max3_f32 v220, v220, v168, v170
    v_max3_f32 v220, v220, v172, v174
    v_max3_f32 v220, v220, v176, v178
    v_max3_f32 v220, v220, v180, v182
    v_max3_f32 v220, v220, v184, v186
    v_max3_f32 v220, v220, v188, v190
    v_mov_b32 v221, v220
    s_nop 1
    v_permlane32_swap_b32 v220, v221
    v_max_f32 v220, v220, v221
    v_sub_f32 v160, v160, v220
    v_sub_f32 v162, v162, v220
    v_sub_f32 v164, v164, v220
    v_sub_f32 v166, v166, v220
    v_sub_f32 v168, v168, v220
    v_sub_f32 v170, v170, v220
    v_sub_f32 v172, v172, v220
    v_sub_f32 v174, v174, v220
    v_sub_f32 v176, v176, v220
    v_sub_f32 v178, v178, v220
    v_sub_f32 v180, v180, v220
    v_sub_f32 v182, v182, v220
    v_sub_f32 v184, v184, v220
    v_sub_f32 v186, v186, v220
    v_sub_f32 v188, v188, v220
    v_sub_f32 v190, v190, v220
    v_exp_f32 v160, v160
    v_exp_f32 v162, v162
    v_exp_f32 v164, v164
    v_exp_f32 v166, v166
    v_exp_f32 v168, v168
    v_exp_f32 v170, v170
    v_exp_f32 v172, v172
    v_exp_f32 v174, v174
    v_exp_f32 v176, v176
    v_exp_f32 v178, v178
    v_exp_f32 v180, v180
    v_exp_f32 v182, v182
    v_exp_f32 v184, v184
    v_exp_f32 v186, v186
    v_exp_f32 v188, v188
    v_exp_f32 v190, v190
    v_mul_f32 v221, v160, v161
    v_fmac_f32 v221, v162, v163
    v_fmac_f32 v221, v164, v165
    v_fmac_f32 v221, v166, v167
    v_fmac_f32 v221, v168, v169
    v_fmac_f32 v221, v170, v171
    v_fmac_f32 v221, v172, v173
    v_fmac_f32 v221, v174, v175
    v_fmac_f32 v221, v176, v177
    v_fmac_f32 v221, v178, v179
    v_fmac_f32 v221, v180, v181
    v_fmac_f32 v221, v182, v183
    v_fmac_f32 v221, v184, v185
    v_fmac_f32 v221, v186, v187
    v_fmac_f32 v221, v188, v189
    v_fmac_f32 v221, v190, v191
    s_branch L_t1lb
L_t1gen:
    s_add_u32 s30, s41, 0
    buffer_load_dwordx2 v[160:161], v219, s[16:19], s30 offen sc1
    s_add_u32 s30, s41, 100352
    buffer_load_dwordx2 v[162:163], v219, s[16:19], s30 offen sc1
    s_add_u32 s30, s41, 200704
    buffer_load_dwordx2 v[164:165], v219, s[16:19], s30 offen sc1
    s_add_u32 s30, s41, 301056
    buffer_load_dwordx2 v[166:167], v219, s[16:19], s30 offen sc1
    s_add_u32 s30, s41, 401408
    buffer_load_dwordx2 v[168:169], v219, s[16:19], s30 offen sc1
    s_add_u32 s30, s41, 501760
    buffer_load_dwordx2 v[170:171], v219, s[16:19], s30 offen sc1
    s_add_u32 s30, s41, 602112
    buffer_load_dwordx2 v[172:173], v219, s[16:19], s30 offen sc1
    s_add_u32 s30, s41, 702464
    buffer_load_dwordx2 v[174:175], v219, s[16:19], s30 offen sc1
    s_add_u32 s30, s41, 802816
    buffer_load_dwordx2 v[176:177], v219, s[16:19], s30 offen sc1
    s_add_u32 s30, s41, 903168
    buffer_load_dwordx2 v[178:179], v219, s[16:19], s30 offen sc1
    s_add_u32 s30, s41, 1003520
    buffer_load_dwordx2 v[180:181], v219, s[16:19], s30 offen sc1
    s_add_u32 s30, s41, 1103872
    buffer_load_dwordx2 v[182:183], v219, s[16:19], s30 offen sc1
    s_add_u32 s30, s41, 1204224
    buffer_load_dwordx2 v[184:185], v219, s[16:19], s30 offen sc1
    s_add_u32 s30, s41, 1304576
    buffer_load_dwordx2 v[186:187], v219, s[16:19], s30 offen sc1
    s_add_u32 s30, s41, 1404928
    buffer_load_dwordx2 v[188:189], v219, s[16:19], s30 offen sc1
    s_add_u32 s30, s41, 1505280
    buffer_load_dwordx2 v[190:191], v219, s[16:19], s30 offen sc1
    s_add_u32 s30, s27, 0
    buffer_load_dwordx4 v[96:99], v212, s[16:19], s30 offen sc1
    s_add_u32 s30, s27, 100352
    buffer_load_dwordx4 v[100:103], v212, s[16:19], s30 offen sc1
    s_add_u32 s30, s27, 200704
    buffer_load_dwordx4 v[104:107], v212, s[16:19], s30 offen sc1
    s_add_u32 s30, s27, 301056
    buffer_load_dwordx4 v[108:111], v212, s[16:19], s30 offen sc1
    s_add_u32 s30, s27, 401408
    buffer_load_dwordx4 v[112:115], v212, s[16:19], s30 offen sc1
    s_add_u32 s30, s27, 501760
    buffer_load_dwordx4 v[116:119], v212, s[16:19], s30 offen sc1
    s_add_u32 s30, s27, 602112
    buffer_load_dwordx4 v[120:123], v212, s[16:19], s30 offen sc1
    s_add_u32 s30, s27, 702464
    buffer_load_dwordx4 v[124:127], v212, s[16:19], s30 offen sc1
    s_add_u32 s30, s27, 802816
    buffer_load_dwordx4 v[128:131], v212, s[16:19], s30 offen sc1
    s_add_u32 s30, s27, 903168
    buffer_load_dwordx4 v[132:135], v212, s[16:19], s30 offen sc1
    s_add_u32 s30, s27, 1003520
    buffer_load_dwordx4 v[136:139], v212, s[16:19], s30 offen sc1
    s_add_u32 s30, s27, 1103872
    buffer_load_dwordx4 v[140:143], v212, s[16:19], s30 offen sc1
    s_add_u32 s30, s27, 1204224
    buffer_load_dwordx4 v[144:147], v212, s[16:19], s30 offen sc1
    s_add_u32 s30, s27, 1304576
    buffer_load_dwordx4 v[148:151], v212, s[16:19], s30 offen sc1
    s_add_u32 s30, s27, 1404928
    buffer_load_dwordx4 v[152:155], v212, s[16:19], s30 offen sc1
    s_add_u32 s30, s27, 1505280
    buffer_load_dwordx4 v[156:159], v212, s[16:19], s30 offen sc1
    s_waitcnt vmcnt(16)
    v_max_f32 v220, v160, v162
    v_max3_f32 v220, v220, v164, v166
    v_max3_f32 v220, v220, v168, v170
    v_max3_f32 v220, v220, v172, v174
    v_max3_f32 v220, v220, v176, v178
    v_max3_f32 v220, v220, v180, v182
    v_max3_f32 v220, v220, v184, v186
    v_max3_f32 v220, v220, v188, v190
    v_mov_b32 v221, v220
    s_nop 1
    v_permlane32_swap_b32 v220, v221
    v_max_f32 v220, v220, v221
    v_sub_f32 v160, v160, v220
    v_sub_f32 v162, v162, v220
    v_sub_f32 v164, v164, v220
    v_sub_f32 v166, v166, v220
    v_sub_f32 v168, v168, v220
    v_sub_f32 v170, v170, v220
    v_sub_f32 v172, v172, v220
    v_sub_f32 v174, v174, v220
    v_sub_f32 v176, v176, v220
    v_sub_f32 v178, v178, v220
    v_sub_f32 v180, v180, v220
    v_sub_f32 v182, v182, v220
    v_sub_f32 v184, v184, v220
    v_sub_f32 v186, v186, v220
    v_sub_f32 v188, v188, v220
    v_sub_f32 v190, v190, v220
    v_exp_f32 v160, v160
    v_exp_f32 v162, v162
    v_exp_f32 v164, v164
    v_exp_f32 v166, v166
    v_exp_f32 v168, v168
    v_exp_f32 v170, v170
    v_exp_f32 v172, v172
    v_exp_f32 v174, v174
    v_exp_f32 v176, v176
    v_exp_f32 v178, v178
    v_exp_f32 v180, v180
    v_exp_f32 v182, v182
    v_exp_f32 v184, v184
    v_exp_f32 v186, v186
    v_exp_f32 v188, v188
    v_exp_f32 v190, v190
    s_waitcnt vmcnt(0)
    v_lshlrev_b32 v32, 16, v96
    v_and_b32 v33, 0xffff0000, v96
    v_lshlrev_b32 v34, 16, v97
    v_and_b32 v35, 0xffff0000, v97
    v_lshlrev_b32 v36, 16, v98
    v_and_b32 v37, 0xffff0000, v98
    v_lshlrev_b32 v38, 16, v99
    v_and_b32 v39, 0xffff0000, v99
    v_pk_mul_f32 v[196:197], v[32:33], v[160:161] op_sel_hi:[1,0]
    v_pk_mul_f32 v[198:199], v[34:35], v[160:161] op_sel_hi:[1,0]
    v_pk_mul_f32 v[200:201], v[36:37], v[160:161] op_sel_hi:[1,0]
    v_pk_mul_f32 v[202:203], v[38:39], v[160:161] op_sel_hi:[1,0]
    v_lshlrev_b32 v32, 16, v100
    v_and_b32 v33, 0xffff0000, v100
    v_lshlrev_b32 v34, 16, v101
    v_and_b32 v35, 0xffff0000, v101
    v_lshlrev_b32 v36, 16, v102
    v_and_b32 v37, 0xffff0000, v102
    v_lshlrev_b32 v38, 16, v103
    v_and_b32 v39, 0xffff0000, v103
    v_pk_fma_f32 v[196:197], v[32:33], v[162:163], v[196:197] op_sel_hi:[1,0,1]
    v_pk_fma_f32 v[198:199], v[34:35], v[162:163], v[198:199] op_sel_hi:[1,0,1]
    v_pk_fma_f32 v[200:201], v[36:37], v[162:163], v[200:201] op_sel_hi:[1,0,1]
    v_pk_fma_f32 v[202:203], v[38:39], v[162:163], v[202:203] op_sel_hi:[1,0,1]
    v_lshlrev_b32 v32, 16, v104
    v_and_b32 v33, 0xffff0000, v104
    v_lshlrev_b32 v34, 16, v105
    v_and_b32 v35, 0xffff0000, v105
    v_lshlrev_b32 v36, 16, v106
    v_and_b32 v37, 0xffff0000, v106
    v_lshlrev_b32 v38, 16, v107
    v_and_b32 v39, 0xffff0000, v107
    v_pk_fma_f32 v[196:197], v[32:33], v[164:165], v[196:197] op_sel_hi:[1,0,1]
    v_pk_fma_f32 v[198:199], v[34:35], v[164:165], v[198:199] op_sel_hi:[1,0,1]
    v_pk_fma_f32 v[200:201], v[36:37], v[164:165], v[200:201] op_sel_hi:[1,0,1]
    v_pk_fma_f32 v[202:203], v[38:39], v[164:165], v[202:203] op_sel_hi:[1,0,1]
    v_lshlrev_b32 v32, 16, v108
    v_and_b32 v33, 0xffff0000, v108
    v_lshlrev_b32 v34, 16, v109
    v_and_b32 v35, 0xffff0000, v109
    v_lshlrev_b32 v36, 16, v110
    v_and_b32 v37, 0xffff0000, v110
    v_lshlrev_b32 v38, 16, v111
    v_and_b32 v39, 0xffff0000, v111
    v_pk_fma_f32 v[196:197], v[32:33], v[166:167], v[196:197] op_sel_hi:[1,0,1]
    v_pk_fma_f32 v[198:199], v[34:35], v[166:167], v[198:199] op_sel_hi:[1,0,1]
    v_pk_fma_f32 v[200:201], v[36:37], v[166:167], v[200:201] op_sel_hi:[1,0,1]
    v_pk_fma_f32 v[202:203], v[38:39], v[166:167], v[202:203] op_sel_hi:[1,0,1]
    v_lshlrev_b32 v32, 16, v112
    v_and_b32 v33, 0xffff0000, v112
    v_lshlrev_b32 v34, 16, v113
    v_and_b32 v35, 0xffff0000, v113
    v_lshlrev_b32 v36, 16, v114
    v_and_b32 v37, 0xffff0000, v114
    v_lshlrev_b32 v38, 16, v115
    v_and_b32 v39, 0xffff0000, v115
    v_pk_fma_f32 v[196:197], v[32:33], v[168:169], v[196:197] op_sel_hi:[1,0,1]
    v_pk_fma_f32 v[198:199], v[34:35], v[168:169], v[198:199] op_sel_hi:[1,0,1]
    v_pk_fma_f32 v[200:201], v[36:37], v[168:169], v[200:201] op_sel_hi:[1,0,1]
    v_pk_fma_f32 v[202:203], v[38:39], v[168:169], v[202:203] op_sel_hi:[1,0,1]
    v_lshlrev_b32 v32, 16, v116
    v_and_b32 v33, 0xffff0000, v116
    v_lshlrev_b32 v34, 16, v117
    v_and_b32 v35, 0xffff0000, v117
    v_lshlrev_b32 v36, 16, v118
    v_and_b32 v37, 0xffff0000, v118
    v_lshlrev_b32 v38, 16, v119
    v_and_b32 v39, 0xffff0000, v119
    v_pk_fma_f32 v[196:197], v[32:33], v[170:171], v[196:197] op_sel_hi:[1,0,1]
    v_pk_fma_f32 v[198:199], v[34:35], v[170:171], v[198:199] op_sel_hi:[1,0,1]
    v_pk_fma_f32 v[200:201], v[36:37], v[170:171], v[200:201] op_sel_hi:[1,0,1]
    v_pk_fma_f32 v[202:203], v[38:39], v[170:171], v[202:203] op_sel_hi:[1,0,1]
    v_lshlrev_b32 v32, 16, v120
    v_and_b32 v33, 0xffff0000, v120
    v_lshlrev_b32 v34, 16, v121
    v_and_b32 v35, 0xffff0000, v121
    v_lshlrev_b32 v36, 16, v122
    v_and_b32 v37, 0xffff0000, v122
    v_lshlrev_b32 v38, 16, v123
    v_and_b32 v39, 0xffff0000, v123
    v_pk_fma_f32 v[196:197], v[32:33], v[172:173], v[196:197] op_sel_hi:[1,0,1]
    v_pk_fma_f32 v[198:199], v[34:35], v[172:173], v[198:199] op_sel_hi:[1,0,1]
    v_pk_fma_f32 v[200:201], v[36:37], v[172:173], v[200:201] op_sel_hi:[1,0,1]
    v_pk_fma_f32 v[202:203], v[38:39], v[172:173], v[202:203] op_sel_hi:[1,0,1]
    v_lshlrev_b32 v32, 16, v124
    v_and_b32 v33, 0xffff0000, v124
    v_lshlrev_b32 v34, 16, v125
    v_and_b32 v35, 0xffff0000, v125
    v_lshlrev_b32 v36, 16, v126
    v_and_b32 v37, 0xffff0000, v126
    v_lshlrev_b32 v38, 16, v127
    v_and_b32 v39, 0xffff0000, v127
    v_pk_fma_f32 v[196:197], v[32:33], v[174:175], v[196:197] op_sel_hi:[1,0,1]
    v_pk_fma_f32 v[198:199], v[34:35], v[174:175], v[198:199] op_sel_hi:[1,0,1]
    v_pk_fma_f32 v[200:201], v[36:37], v[174:175], v[200:201] op_sel_hi:[1,0,1]
    v_pk_fma_f32 v[202:203], v[38:39], v[174:175], v[202:203] op_sel_hi:[1,0,1]
    v_lshlrev_b32 v32, 16, v128
    v_and_b32 v33, 0xffff0000, v128
    v_lshlrev_b32 v34, 16, v129
    v_and_b32 v35, 0xffff0000, v129
    v_lshlrev_b32 v36, 16, v130
    v_and_b32 v37, 0xffff0000, v130
    v_lshlrev_b32 v38, 16, v131
    v_and_b32 v39, 0xffff0000, v131
    v_pk_fma_f32 v[196:197], v[32:33], v[176:177], v[196:197] op_sel_hi:[1,0,1]
    v_pk_fma_f32 v[198:199], v[34:35], v[176:177], v[198:199] op_sel_hi:[1,0,1]
    v_pk_fma_f32 v[200:201], v[36:37], v[176:177], v[200:201] op_sel_hi:[1,0,1]
    v_pk_fma_f32 v[202:203], v[38:39], v[176:177], v[202:203] op_sel_hi:[1,0,1]
    v_lshlrev_b32 v32, 16, v132
    v_and_b32 v33, 0xffff0000, v132
    v_lshlrev_b32 v34, 16, v133
    v_and_b32 v35, 0xffff0000, v133
    v_lshlrev_b32 v36, 16, v134
    v_and_b32 v37, 0xffff0000, v134
    v_lshlrev_b32 v38, 16, v135
    v_and_b32 v39, 0xffff0000, v135
    v_pk_fma_f32 v[196:197], v[32:33], v[178:179], v[196:197] op_sel_hi:[1,0,1]
    v_pk_fma_f32 v[198:199], v[34:35], v[178:179], v[198:199] op_sel_hi:[1,0,1]
    v_pk_fma_f32 v[200:201], v[36:37], v[178:179], v[200:201] op_sel_hi:[1,0,1]
    v_pk_fma_f32 v[202:203], v[38:39], v[178:179], v[202:203] op_sel_hi:[1,0,1]
    v_lshlrev_b32 v32, 16, v136
    v_and_b32 v33, 0xffff0000, v136
    v_lshlrev_b32 v34, 16, v137
    v_and_b32 v35, 0xffff0000, v137
    v_lshlrev_b32 v36, 16, v138
    v_and_b32 v37, 0xffff0000, v138
    v_lshlrev_b32 v38, 16, v139
    v_and_b32 v39, 0xffff0000, v139
    v_pk_fma_f32 v[196:197], v[32:33], v[180:181], v[196:197] op_sel_hi:[1,0,1]
    v_pk_fma_f32 v[198:199], v[34:35], v[180:181], v[198:199] op_sel_hi:[1,0,1]
    v_pk_fma_f32 v[200:201], v[36:37], v[180:181], v[200:201] op_sel_hi:[1,0,1]
    v_pk_fma_f32 v[202:203], v[38:39], v[180:181], v[202:203] op_sel_hi:[1,0,1]
    v_lshlrev_b32 v32, 16, v140
    v_and_b32 v33, 0xffff0000, v140
    v_lshlrev_b32 v34, 16, v141
    v_and_b32 v35, 0xffff0000, v141
    v_lshlrev_b32 v36, 16, v142
    v_and_b32 v37, 0xffff0000, v142
    v_lshlrev_b32 v38, 16, v143
    v_and_b32 v39, 0xffff0000, v143
    v_pk_fma_f32 v[196:197], v[32:33], v[182:183], v[196:197] op_sel_hi:[1,0,1]
    v_pk_fma_f32 v[198:199], v[34:35], v[182:183], v[198:199] op_sel_hi:[1,0,1]
    v_pk_fma_f32 v[200:201], v[36:37], v[182:183], v[200:201] op_sel_hi:[1,0,1]
    v_pk_fma_f32 v[202:203], v[38:39], v[182:183], v[202:203] op_sel_hi:[1,0,1]
    v_lshlrev_b32 v32, 16, v144
    v_and_b32 v33, 0xffff0000, v144
    v_lshlrev_b32 v34, 16, v145
    v_and_b32 v35, 0xffff0000, v145
    v_lshlrev_b32 v36, 16, v146
    v_and_b32 v37, 0xffff0000, v146
    v_lshlrev_b32 v38, 16, v147
    v_and_b32 v39, 0xffff0000, v147
    v_pk_fma_f32 v[196:197], v[32:33], v[184:185], v[196:197] op_sel_hi:[1,0,1]
    v_pk_fma_f32 v[198:199], v[34:35], v[184:185], v[198:199] op_sel_hi:[1,0,1]
    v_pk_fma_f32 v[200:201], v[36:37], v[184:185], v[200:201] op_sel_hi:[1,0,1]
    v_pk_fma_f32 v[202:203], v[38:39], v[184:185], v[202:203] op_sel_hi:[1,0,1]
    v_lshlrev_b32 v32, 16, v148
    v_and_b32 v33, 0xffff0000, v148
    v_lshlrev_b32 v34, 16, v149
    v_and_b32 v35, 0xffff0000, v149
    v_lshlrev_b32 v36, 16, v150
    v_and_b32 v37, 0xffff0000, v150
    v_lshlrev_b32 v38, 16, v151
    v_and_b32 v39, 0xffff0000, v151
    v_pk_fma_f32 v[196:197], v[32:33], v[186:187], v[196:197] op_sel_hi:[1,0,1]
    v_pk_fma_f32 v[198:199], v[34:35], v[186:187], v[198:199] op_sel_hi:[1,0,1]
    v_pk_fma_f32 v[200:201], v[36:37], v[186:187], v[200:201] op_sel_hi:[1,0,1]
    v_pk_fma_f32 v[202:203], v[38:39], v[186:187], v[202:203] op_sel_hi:[1,0,1]
    v_lshlrev_b32 v32, 16, v152
    v_and_b32 v33, 0xffff0000, v152
    v_lshlrev_b32 v34, 16, v153
    v_and_b32 v35, 0xffff0000, v153
    v_lshlrev_b32 v36, 16, v154
    v_and_b32 v37, 0xffff0000, v154
    v_lshlrev_b32 v38, 16, v155
    v_and_b32 v39, 0xffff0000, v155
    v_pk_fma_f32 v[196:197], v[32:33], v[188:189], v[196:197] op_sel_hi:[1,0,1]
    v_pk_fma_f32 v[198:199], v[34:35], v[188:189], v[198:199] op_sel_hi:[1,0,1]
    v_pk_fma_f32 v[200:201], v[36:37], v[188:189], v[200:201] op_sel_hi:[1,0,1]
    v_pk_fma_f32 v[202:203], v[38:39], v[188:189], v[202:203] op_sel_hi:[1,0,1]
    v_lshlrev_b32 v32, 16, v156
    v_and_b32 v33, 0xffff0000, v156
    v_lshlrev_b32 v34, 16, v157
    v_and_b32 v35, 0xffff0000, v157
    v_lshlrev_b32 v36, 16, v158
    v_and_b32 v37, 0xffff0000, v158
    v_lshlrev_b32 v38, 16, v159
    v_and_b32 v39, 0xffff0000, v159
    v_pk_fma_f32 v[196:197], v[32:33], v[190:191], v[196:197] op_sel_hi:[1,0,1]
    v_pk_fma_f32 v[198:199], v[34:35], v[190:191], v[198:199] op_sel_hi:[1,0,1]
    v_pk_fma_f32 v[200:201], v[36:37], v[190:191], v[200:201] op_sel_hi:[1,0,1]
    v_pk_fma_f32 v[202:203], v[38:39], v[190:191], v[202:203] op_sel_hi:[1,0,1]
    s_nop 1
    v_permlane32_swap_b32 v196, v32
    v_permlane32_swap_b32 v197, v33
    v_permlane32_swap_b32 v198, v34
    v_permlane32_swap_b32 v199, v35
    v_permlane32_swap_b32 v200, v36
    v_permlane32_swap_b32 v201, v37
    v_permlane32_swap_b32 v202, v38
    v_permlane32_swap_b32 v203, v39
    v_add_f32 v196, v196, v32
    v_add_f32 v197, v197, v33
    v_add_f32 v198, v198, v34
    v_add_f32 v199, v199, v35
    v_add_f32 v200, v200, v36
    v_add_f32 v201, v201, v37
    v_add_f32 v202, v202, v38
    v_add_f32 v203, v203, v39
    s_branch L_t1back
L_s_hook:
Lw_14:
    s_cbranch_execz Lw_ret
    s_cmp_lt_u32 s25, 9
    s_cbranch_scc1 L_hd
    s_cmp_lg_u32 s49, 0
    s_cbranch_scc1 L_s_last
    v_readfirstlane_b32 s27, v31
    s_cmp_lt_i32 s27, 0
    s_cbranch_scc1 L_s_dry
    s_bitcmp1_b32 s27, 30
    s_cbranch_scc1 L_s_one
    s_add_u32 s27, s27, 1
    s_mul_hi_u32 s30, s27, 178956971
    s_mul_i32 s30, s30, 24
    s_add_u32 s26, s27, s30
    s_lshl1_add_u32 s26, s26, s42
    s_mulk_i32 s26, 6144
    s_lshl2_add_u32 s27, s27, s3
    s_mulk_i32 s27, 1536
L_hd:
    s_cmp_lt_u32 s25, s58
    s_cbranch_scc1 L_h1
    s_mov_b32 s50, 1
    s_atomic_add s50, s[16:17], s51 glc
L_h1:
    s_cmp_lg_u32 s25, s46
    s_cbranch_scc1 L_hu0
    v_add_u32 v94, s24, v10
    ds_write_b128 v94, v[192:195]
    v_add_u32 v95, s24, v11
    ds_write_b128 v95, v[196:199]
    v_add_u32 v94, s24, v12
    ds_write_b128 v94, v[200:203]
    v_add_u32 v95, s24, v13
    ds_write_b128 v95, v[204:207]
    v_add_u32 v94, s24, v14
    ds_write_b128 v94, v[208:211]
    v_add_u32 v95, s24, v15
    ds_write_b128 v95, v[212:215]
    s_add_u32 s43, s24, s34
    s_add_u32 s43, s43, 5120
    v_add_u32 v94, s43, v16
    ds_write_b128 v94, v[216:219]
    v_add_u32 v95, s43, v17
    s_mov_b32 exec_hi, 0
    ds_write_b128 v95, v[220:223]
    s_mov_b32 exec_hi, -1
    s_waitcnt vmcnt(0) lgkmcnt(0)
    s_branch L_s_next
L_hu0:
    s_cmp_lg_u32 s25, s47
    s_cbranch_scc1 L_s_dma
    v_add_u32 v94, s24, v10
    ds_write_b128 v94, v[224:227]
    v_add_u32 v95, s24, v11
    ds_write_b128 v95, v[228:231]
    v_add_u32 v94, s24, v12
    ds_write_b128 v94, v[232:235]
    v_add_u32 v95, s24, v13
    ds_write_b128 v95, v[236:239]
    v_add_u32 v94, s24, v14
    ds_write_b128 v94, v[240:243]
    v_add_u32 v95, s24, v15
    ds_write_b128 v95, v[244:247]
    s_add_u32 s43, s24, s34
    s_add_u32 s43, s43, 5120
    v_add_u32 v94, s43, v16
    ds_write_b128 v94, v[248:251]
    v_add_u32 v95, s43, v17
    s_mov_b32 exec_hi, 0
    ds_write_b128 v95, v[252:255]
    s_mov_b32 exec_hi, -1
    s_waitcnt vmcnt(0) lgkmcnt(0)
    s_branch L_s_next
L_hu1:
L_s_one:
    s_mov_b32 s46, -1
    s_movk_i32 s50, 0x7fff
    v_mov_b32 v9, s50
    s_waitcnt vmcnt(0)
    s_branch L_s_next
L_s_dry:
    s_mov_b32 s49, 1
    s_mov_b32 s58, 64
    s_lshr_b32 s30, s46, 31
    s_and_b32 s30, s30, s4
    s_cbranch_scc0 L_s_dry2
    v_mov_b32 v32, 0xff600000
    v_mov_b32 v33, 0xff600000
    v_mov_b32 v34, 0xff600000
    v_mov_b32 v35, 0xff600000
L_s_dry2:
    v_lshlrev_b32 v215, 2, v0
    s_bfe_u32 s41, s37, 0x20002
    s_lshl_b32 s40, s36, 2
    s_add_u32 s40, s40, s41
    s_lshl_b32 s40, s40, 7
    s_add_u32 s40, s40, 577536
    v_lshrrev_b32 v216, 5, v0
    v_and_b32 v220, 31, v0
    v_lshlrev_b32 v218, 4, v220
    s_mov_b32 s43, 50176
    v_mad_u32_u24 v212, v216, s43, v218
    v_lshlrev_b32 v220, 3, v220
    v_mad_u32_u24 v219, v216, s43, v220
    s_lshl_b32 s41, s41, 8
    s_add_u32 s41, s41, s38
    s_add_u32 s41, s41, 49152
    s_mul_i32 s42, s37, 3
Lw_15:
    s_cbranch_execz Lw_ret
    s_add_u32 s42, s42, s3
    s_lshl_b32 s27, s42, 9
    s_add_u32 s27, s27, s38
    v_bfrev_b32 v213, 1
    v_lshlrev_b32 v217, 3, v216
    v_and_b32 v220, 1, v0
    v_lshlrev_b32 v220, 4, v220
    s_movk_i32 s30, 0x3f80
    v_lshlrev_b32 v220, v220, s30
    v_bfe_u32 v221, v0, 1, 4
    v_cmp_eq_u32 vcc, 0, v221
    v_mov_b64 v[196:197], 0
    v_mov_b64 v[198:199], 0
    v_cndmask_b32 v192, 0, v220, vcc
    v_cmp_eq_u32 vcc, 1, v221
    v_mov_b64 v[200:201], 0
    v_mov_b64 v[202:203], 0
    v_cndmask_b32 v193, 0, v220, vcc
    v_cmp_eq_u32 vcc, 4, v221
    v_mov_b64 v[204:205], 0
    v_mov_b64 v[206:207], 0
    v_cndmask_b32 v194, 0, v220, vcc
    v_cmp_eq_u32 vcc, 5, v221
    v_mov_b64 v[208:209], 0
    v_mov_b64 v[210:211], 0
    v_cndmask_b32 v195, 0, v220, vcc
    s_lshr_b32 s26, s42, 2
    s_mul_i32 s26, s26, 6
    s_add_u32 s26, s26, s36
    s_lshl_b32 s26, s26, 2
    s_and_b32 s30, s42, 3
    s_add_u32 s26, s26, s30
    s_lshl_b32 s26, s26, 8
    s_add_u32 s26, s26, 278528
    v_bfe_u32 v222, v0, 4, 1
    v_mul_u32_u24 v222, 147200, v222
    v_add_u32 v222, v222, v218
    s_waitcnt vmcnt(0)
    s_branch L_s_next
L_s_post:
    s_cmp_eq_u32 s25, 7
    s_cbranch_scc1 L_draw
    s_waitcnt lgkmcnt(0)
    s_mov_b32 s30, s50
    s_add_u32 s30, s30, 1
    s_mul_i32 s56, s30, 4
    s_add_u32 s56, s56, s48
    s_add_u32 s57, s56, 1073746192
    s_cmp_lt_u32 s30, 60
    s_cselect_b32 s57, s57, -1
    s_lshl1_add_u32 s56, s56, 4224
    s_cmp_lt_u32 s30, 36
    s_cselect_b32 s56, s56, s57
    v_mov_b32 v94, s56
    ds_write_b32 v30, v94
    s_waitcnt lgkmcnt(0)
    s_cbranch_scc0 L_s_postb
L_draw:
    s_branch L_s_postb
L_ew_8_r:
    s_sleep 2
    s_mov_b64 exec, 1
    buffer_load_dwordx4 v[2:5], off, s[20:23], s60 sc1
    s_mov_b64 exec, -1
    s_waitcnt vmcnt(0)
    s_sub_u32 s61, s61, 1
    s_cmp_gt_i32 s61, 0
    s_cbranch_scc1 L_ew_8
    s_branch L_ew_8_d
L_aretry:
    v_min_u32 v3, 47, v0
    v_lshlrev_b32 v3, 9, v3
L_aw:
    s_sub_u32 s61, s61, 1
    s_cmp_gt_i32 s61, 0
    s_cbranch_scc0 L_aok
    buffer_load_dword v2, v3, s[16:19], s52 offen sc1
    s_waitcnt vmcnt(0)
    v_cmp_eq_u32 vcc, -1, v2
    s_cbranch_vccz L_aload
    s_sleep 4
    s_branch L_aw
L_aload:
    buffer_load_dwordx4 v[96:99], v6, s[16:19], s52 offen offset:0 sc1
    buffer_load_dwordx4 v[100:103], v6, s[16:19], s52 offen offset:1024 sc1
    buffer_load_dwordx4 v[104:107], v6, s[16:19], s52 offen offset:2048 sc1
    buffer_load_dwordx4 v[108:111], v6, s[16:19], s52 offen offset:3072 sc1
    buffer_load_dwordx4 v[112:115], v6, s[16:19], s53 offen offset:0 sc1
    buffer_load_dwordx4 v[116:119], v6, s[16:19], s53 offen offset:1024 sc1
    buffer_load_dwordx4 v[120:123], v6, s[16:19], s53 offen offset:2048 sc1
    buffer_load_dwordx4 v[124:127], v6, s[16:19], s53 offen offset:3072 sc1
    buffer_load_dwordx4 v[128:131], v6, s[16:19], s54 offen offset:0 sc1
    buffer_load_dwordx4 v[132:135], v6, s[16:19], s54 offen offset:1024 sc1
    buffer_load_dwordx4 v[136:139], v6, s[16:19], s54 offen offset:2048 sc1
    buffer_load_dwordx4 v[140:143], v6, s[16:19], s54 offen offset:3072 sc1
    buffer_load_dwordx4 v[144:147], v6, s[16:19], s55 offen offset:0 sc1
    buffer_load_dwordx4 v[148:151], v6, s[16:19], s55 offen offset:1024 sc1
    buffer_load_dwordx4 v[152:155], v6, s[16:19], s55 offen offset:2048 sc1
    buffer_load_dwordx4 v[156:159], v6, s[16:19], s55 offen offset:3072 sc1
    buffer_load_dwordx4 v[160:163], v6, s[16:19], s56 offen offset:0 sc1
    buffer_load_dwordx4 v[164:167], v6, s[16:19], s56 offen offset:1024 sc1
    buffer_load_dwordx4 v[168:171], v6, s[16:19], s56 offen offset:2048 sc1
    buffer_load_dwordx4 v[172:175], v6, s[16:19], s56 offen offset:3072 sc1
    buffer_load_dwordx4 v[176:179], v6, s[16:19], s57 offen offset:0 sc1
    buffer_load_dwordx4 v[180:183], v6, s[16:19], s57 offen offset:1024 sc1
    buffer_load_dwordx4 v[184:187], v6, s[16:19], s57 offen offset:2048 sc1
Lw_16:
    s_cbranch_execz Lw_ret
    buffer_load_dwordx4 v[188:191], v6, s[16:19], s57 offen offset:3072 sc1
    s_waitcnt vmcnt(23)
    v_max_u32 v2, v96, v97
    v_max3_u32 v2, v2, v98, v99
    s_waitcnt vmcnt(22)
    v_max3_u32 v2, v2, v100, v101
    v_max3_u32 v2, v2, v102, v103
    s_waitcnt vmcnt(21)
    v_max3_u32 v2, v2, v104, v105
    v_max3_u32 v2, v2, v106, v107
    s_waitcnt vmcnt(20)
    v_max3_u32 v2, v2, v108, v109
    v_max3_u32 v2, v2, v110, v111
    s_waitcnt vmcnt(19)
    v_max3_u32 v2, v2, v112, v113
    v_max3_u32 v2, v2, v114, v115
    s_waitcnt vmcnt(18)
    v_max3_u32 v2, v2, v116, v117
    v_max3_u32 v2, v2, v118, v119
    s_waitcnt vmcnt(17)
    v_max3_u32 v2, v2, v120, v121
    v_max3_u32 v2, v2, v122, v123
    s_waitcnt vmcnt(16)
    v_max3_u32 v2, v2, v124, v125
    v_max3_u32 v2, v2, v126, v127
    s_waitcnt vmcnt(15)
    v_max3_u32 v2, v2, v128, v129
    v_max3_u32 v2, v2, v130, v131
    s_waitcnt vmcnt(14)
    v_max3_u32 v2, v2, v132, v133
    v_max3_u32 v2, v2, v134, v135
    s_waitcnt vmcnt(13)
    v_max3_u32 v2, v2, v136, v137
    v_max3_u32 v2, v2, v138, v139
    s_waitcnt vmcnt(12)
    v_max3_u32 v2, v2, v140, v141
    v_max3_u32 v2, v2, v142, v143
    s_waitcnt vmcnt(11)
    v_max3_u32 v2, v2, v144, v145
    v_max3_u32 v2, v2, v146, v147
    s_waitcnt vmcnt(10)
    v_max3_u32 v2, v2, v148, v149
    v_max3_u32 v2, v2, v150, v151
    s_waitcnt vmcnt(9)
    v_max3_u32 v2, v2, v152, v153
    v_max3_u32 v2, v2, v154, v155
    s_waitcnt vmcnt(8)
    v_max3_u32 v2, v2, v156, v157
    v_max3_u32 v2, v2, v158, v159
    s_waitcnt vmcnt(7)
    v_max3_u32 v2, v2, v160, v161
    v_max3_u32 v2, v2, v162, v163
    s_waitcnt vmcnt(6)
    v_max3_u32 v2, v2, v164, v165
    v_max3_u32 v2, v2, v166, v167
    s_waitcnt vmcnt(5)
    v_max3_u32 v2, v2, v168, v169
    v_max3_u32 v2, v2, v170, v171
    s_waitcnt vmcnt(4)
    v_max3_u32 v2, v2, v172, v173
    v_max3_u32 v2, v2, v174, v175
    s_waitcnt vmcnt(3)
    v_max3_u32 v2, v2, v176, v177
    v_max3_u32 v2, v2, v178, v179
    s_waitcnt vmcnt(2)
    v_max3_u32 v2, v2, v180, v181
    v_max3_u32 v2, v2, v182, v183
    s_waitcnt vmcnt(1)
    v_max3_u32 v2, v2, v184, v185
    v_max3_u32 v2, v2, v186, v187
    s_waitcnt vmcnt(0)
    v_max3_u32 v2, v2, v188, v189
    v_max3_u32 v2, v2, v190, v191
    v_cmp_eq_u32 vcc, -1, v2
    s_cbranch_vccnz L_aretry
    s_branch L_aok
L_s_slow:
    s_cmp_eq_u64 s[28:29], 0
    s_cbranch_scc1 L_sf_go
    v_cmp_ne_u32 s[56:57], 0, v88
    v_pk_max_u16 v88, v48, v49
    v_pk_max_u16 v89, v50, v51
    v_pk_max_u16 v88, v88, v89
    v_lshlrev_b32 v89, 16, v88
    v_max_u32 v88, v88, v89
    v_cmp_gt_u32 vcc, 0x2b800000, v88
    s_or_b64 vcc, vcc, s[56:57]
    s_cbranch_scc1 L_sf_go
    s_mov_b64 s[28:29], 0
    s_branch L_s_back
L_sf_go:
    v_max3_f32 v88, v40, v41, v42
    v_max3_f32 v88, v88, v43, v44
    v_max3_f32 v88, v88, v45, v46
    v_max_f32 v88, v88, v47
    v_mov_b32 v89, v88
    s_nop 1
    v_permlane16_swap_b32 v88, v89
    v_max_f32 v88, v88, v89
    v_mov_b32 v89, v88
    s_nop 1
    v_permlane32_swap_b32 v88, v89
Lw_17:
    s_cbranch_execz Lw_ret
    v_max_f32 v88, v88, v89
    s_lshl_b32 s30, s4, 7
    v_add_u32 v91, s30, v29
    ds_write_b32 v91, v88
    s_waitcnt lgkmcnt(0)
    s_barrier
    ds_read2_b32 v[88:89], v29 offset0:0 offset1:32
    s_waitcnt lgkmcnt(0)
    v_max_f32 v88, v88, v89
    v_add_f32 v88, 4.0, v88
    v_mul_f32 v88, 0x3d800000, v88
    v_ceil_f32 v88, v88
    v_mul_f32 v88, 0x41800000, v88
    v_max_f32 v89, 0, v88
    v_cndmask_b32 v88, v89, v88, s[28:29]
    s_mov_b64 s[28:29], 0
    v_sub_f32 v32, v32, v88
    v_sub_f32 v40, v40, v88
    v_sub_f32 v44, v44, v88
    v_sub_f32 v33, v33, v88
    v_sub_f32 v41, v41, v88
    v_sub_f32 v45, v45, v88
    v_sub_f32 v34, v34, v88
    v_sub_f32 v42, v42, v88
    v_sub_f32 v46, v46, v88
    v_sub_f32 v35, v35, v88
    v_sub_f32 v43, v43, v88
    v_sub_f32 v47, v47, v88
    v_exp_f32 v88, v40
    v_exp_f32 v89, v41
    v_exp_f32 v90, v42
    v_exp_f32 v91, v43
    v_add_f32 v92, v88, v89
    v_add_f32 v93, v90, v91
    v_cvt_pk_bf16_f32 v52, v88, v89
    v_cvt_pk_bf16_f32 v53, v90, v91
    v_add_f32 v92, v92, v93
    ds_write_b64 v26, v[52:53] offset:0
    v_cvt_pk_bf16_f32 v54, v92, v92
    ds_write_b16 v27, v54 offset:0
    v_exp_f32 v88, v44
    v_exp_f32 v89, v45
    v_exp_f32 v90, v46
    v_exp_f32 v91, v47
    v_add_f32 v92, v88, v89
    v_add_f32 v93, v90, v91
    v_cvt_pk_bf16_f32 v52, v88, v89
    v_cvt_pk_bf16_f32 v53, v90, v91
    v_add_f32 v92, v92, v93
    ds_write_b64 v26, v[52:53] offset:1024
    v_cvt_pk_bf16_f32 v54, v92, v92
    ds_write_b16 v27, v54 offset:512
    s_waitcnt lgkmcnt(0)
    s_barrier
    s_branch L_s_back
L_spare:
    s_mov_b32 s18, 452984832
    s_mov_b32 s19, 0x20000
    s_mov_b32 s22, 256
    s_mov_b32 s23, 0x20000
    s_mov_b32 s61, 2000000
    s_and_b32 s4, s2, 1
    s_bfe_u32 s5, s2, 0x10001
    v_lshlrev_b32 v2, 4, v0
    v_mov_b64 v[4:5], -1
    v_mov_b64 v[6:7], -1
    v_mov_b32 v8, 1
    s_mul_i32 s36, s4, 12288
    s_lshl_b32 s36, s36, s5
    s_mul_i32 s30, s7, 3072
    s_add_u32 s36, s36, s30
    s_cmp_ge_u32 s7, 4
    s_cselect_b32 s30, 12288, 0
    s_cmp_lg_u32 s5, 0
    s_cselect_b32 s30, 49152, s30
    s_add_u32 s36, s36, s30
    s_waitcnt lgkmcnt(0)
    buffer_store_dwordx4 v[4:7], v2, s[16:19], s36 offen offset:0 sc1
    buffer_store_dwordx4 v[4:7], v2, s[16:19], s36 offen offset:1024 sc1
    buffer_store_dwordx4 v[4:7], v2, s[16:19], s36 offen offset:2048 sc1
    s_lshl3_add_u32 s30, s2, s7
    s_cmp_lg_u32 s30, 503
    s_cbranch_scc1 L_ntk
    s_mov_b32 s30, 622592
    buffer_store_dwordx4 v[4:7], v2, s[16:19], s30 offen sc1
    buffer_store_dwordx4 v[4:7], v2, s[16:19], s30 offen offset:1024 sc1
L_ntk:
    s_lshl_b32 s38, s4, 7
    s_lshl_b32 s30, s5, 2
    s_add_u32 s38, s38, s30
    s_and_b32 s36, s2, 3
    s_lshl_b32 s36, s36, 3
    s_add_u32 s36, s36, s7
    s_lshl_b32 s36, s36, 14
    s_add_u32 s36, s36, 98304
    s_waitcnt vmcnt(0)
    s_barrier
    s_cmp_lg_u32 s7, 0
    s_cbranch_scc1 L_sp_9
    s_mov_b64 exec, 1
    buffer_store_dword v8, off, s[20:23], s38 offset:0 sc1
    s_mov_b64 exec, -1
L_sp_9:
    s_cmp_lg_u32 s7, 0
    s_cbranch_scc1 L_aw_10_d
L_aw_10_f:
    s_sleep 32
    s_lshl_b32 s60, s4, 7
    s_mov_b64 exec, 1
    buffer_load_dwordx4 v[12:15], off, s[20:23], s60 sc1
    s_mov_b64 exec, -1
    s_waitcnt vmcnt(0)
    v_readfirstlane_b32 s30, v13
    s_cmp_lg_u32 s30, 0
    s_cbranch_scc1 L_aw_10_g
    s_sub_u32 s61, s61, 1
    s_cmp_gt_i32 s61, 0
    s_cbranch_scc1 L_aw_10_f
L_aw_10_g:
    s_mul_i32 s30, s4, 24576
    s_add_u32 s30, s30, 49152
    s_mov_b64 exec, 1
L_aw_10:
    s_sleep 8
    buffer_load_dword v9, off, s[16:19], s30 offset:256 sc1
    s_waitcnt vmcnt(0)
    v_cmp_ne_u32 vcc, -1, v9
    s_cbranch_vccnz L_aw_10_x
    s_sub_u32 s61, s61, 1
    s_cmp_gt_i32 s61, 0
    s_cbranch_scc1 L_aw_10
L_aw_10_x:
    s_mov_b64 exec, -1
L_aw_10_d:
    s_barrier
    buffer_store_dwordx4 v[4:7], v2, s[16:19], s36 offen offset:0 sc1
    buffer_store_dwordx4 v[4:7], v2, s[16:19], s36 offen offset:1024 sc1
    buffer_store_dwordx4 v[4:7], v2, s[16:19], s36 offen offset:2048 sc1
    buffer_store_dwordx4 v[4:7], v2, s[16:19], s36 offen offset:3072 sc1
    s_add_u32 s36, s36, 4096
    buffer_store_dwordx4 v[4:7], v2, s[16:19], s36 offen offset:0 sc1
    buffer_store_dwordx4 v[4:7], v2, s[16:19], s36 offen offset:1024 sc1
    buffer_store_dwordx4 v[4:7], v2, s[16:19], s36 offen offset:2048 sc1
    buffer_store_dwordx4 v[4:7], v2, s[16:19], s36 offen offset:3072 sc1
    s_add_u32 s36, s36, 4096
    buffer_store_dwordx4 v[4:7], v2, s[16:19], s36 offen offset:0 sc1
    buffer_store_dwordx4 v[4:7], v2, s[16:19], s36 offen offset:1024 sc1
    buffer_store_dwordx4 v[4:7], v2, s[16:19], s36 offen offset:2048 sc1
    buffer_store_dwordx4 v[4:7], v2, s[16:19], s36 offen offset:3072 sc1
    s_add_u32 s36, s36, 4096
    buffer_store_dwordx4 v[4:7], v2, s[16:19], s36 offen offset:0 sc1
    buffer_store_dwordx4 v[4:7], v2, s[16:19], s36 offen offset:1024 sc1
    buffer_store_dwordx4 v[4:7], v2, s[16:19], s36 offen offset:2048 sc1
    buffer_store_dwordx4 v[4:7], v2, s[16:19], s36 offen offset:3072 sc1
    s_add_u32 s36, s36, 4096
    s_waitcnt vmcnt(0)
    s_barrier
    s_cmp_lg_u32 s7, 0
    s_cbranch_scc1 L_sp_11
    s_mov_b64 exec, 1
    buffer_store_dword v8, off, s[20:23], s38 offset:16 sc1
    s_mov_b64 exec, -1
L_sp_11:
    s_branch L_fin
L_pf:
    s_mov_b32 s18, 452984832
    s_mov_b32 s19, 0x20000
    s_mov_b32 s22, 256
    s_mov_b32 s23, 0x20000
    s_mov_b32 s61, 2000000
    s_waitcnt lgkmcnt(0)
    s_load_dwordx2 s[8:9], s[0:1], 24
    s_load_dwordx2 s[12:13], s[0:1], 32
    s_mov_b32 s10, 294912
    s_mov_b32 s11, 0x20000
    s_mov_b32 s14, 294912
    s_mov_b32 s15, 0x20000
    s_sub_u32 s5, s2, 48
    s_lshr_b32 s5, s5, 1
    s_lshl_b32 s5, s5, 1
    s_and_b32 s30, s3, 1
    s_add_u32 s5, s5, s30
    s_mul_i32 s5, s5, 24576
    v_lshlrev_b32 v2, 7, v0
    s_waitcnt lgkmcnt(0) vmcnt(0)
    s_cmp_ge_u32 s3, 2
    s_cselect_b64 s[8:9], s[12:13], s[8:9]
    s_add_u32 s30, s5, 0
    buffer_load_dword v3, v2, s[8:11], s30 offen
    s_add_u32 s30, s5, 8192
    buffer_load_dword v3, v2, s[8:11], s30 offen
    s_add_u32 s30, s5, 16384
    buffer_load_dword v3, v2, s[8:11], s30 offen
    s_load_dwordx2 s[8:9], s[0:1], 64
    s_load_dwordx2 s[12:13], s[0:1], 72
    s_mov_b32 s10, 1179648
    s_mov_b32 s11, 0x20000
    s_mov_b32 s14, 1179648
    s_mov_b32 s15, 0x20000
    s_and_b32 s4, s2, 1
    s_sub_u32 s5, s2, 48
    s_lshr_b32 s5, s5, 1
    s_lshl_b32 s5, s5, 2
    s_add_u32 s5, s5, s3
    s_mul_i32 s5, s5, 49152
    v_lshlrev_b32 v2, 7, v0
    s_cmp_lg_u32 s7, 0
    s_cbranch_scc1 L_aw_12_d
L_aw_12_f:
    s_sleep 32
    s_lshl_b32 s60, s4, 7
    s_mov_b64 exec, 1
    buffer_load_dwordx4 v[12:15], off, s[20:23], s60 sc1
    s_mov_b64 exec, -1
    s_waitcnt vmcnt(0)
    v_readfirstlane_b32 s30, v13
    s_cmp_lg_u32 s30, 0
    s_cbranch_scc1 L_aw_12_g
    s_sub_u32 s61, s61, 1
    s_cmp_gt_i32 s61, 0
    s_cbranch_scc1 L_aw_12_f
L_aw_12_g:
    s_mul_i32 s30, s4, 24576
    s_add_u32 s30, s30, 49152
    s_mov_b64 exec, 1
L_aw_12:
    s_sleep 8
    buffer_load_dword v9, off, s[16:19], s30 offset:256 sc1
    s_waitcnt vmcnt(0)
    v_cmp_ne_u32 vcc, -1, v9
    s_cbranch_vccnz L_aw_12_x
    s_sub_u32 s61, s61, 1
    s_cmp_gt_i32 s61, 0
    s_cbranch_scc1 L_aw_12
L_aw_12_x:
    s_mov_b64 exec, -1
L_aw_12_d:
    s_barrier
    s_waitcnt lgkmcnt(0)
    s_cmp_eq_u32 s4, 0
    s_cselect_b64 s[24:25], s[8:9], s[12:13]
    s_cselect_b64 s[8:9], s[12:13], s[8:9]
    s_add_u32 s30, s5, 0
    buffer_load_dword v3, v2, s[8:11], s30 offen
    s_add_u32 s30, s5, 8192
    buffer_load_dword v3, v2, s[8:11], s30 offen
    s_add_u32 s30, s5, 16384
    buffer_load_dword v3, v2, s[8:11], s30 offen
    s_add_u32 s30, s5, 24576
    buffer_load_dword v3, v2, s[8:11], s30 offen
    s_add_u32 s30, s5, 32768
    buffer_load_dword v3, v2, s[8:11], s30 offen
    s_add_u32 s30, s5, 40960
    buffer_load_dword v3, v2, s[8:11], s30 offen
    s_mov_b64 s[8:9], s[24:25]
    s_add_u32 s30, s5, 0
    buffer_load_dword v3, v2, s[8:11], s30 offen
    s_add_u32 s30, s5, 8192
    buffer_load_dword v3, v2, s[8:11], s30 offen
    s_add_u32 s30, s5, 16384
    buffer_load_dword v3, v2, s[8:11], s30 offen
    s_add_u32 s30, s5, 24576
    buffer_load_dword v3, v2, s[8:11], s30 offen
    s_add_u32 s30, s5, 32768
    buffer_load_dword v3, v2, s[8:11], s30 offen
    s_add_u32 s30, s5, 40960
    buffer_load_dword v3, v2, s[8:11], s30 offen
    s_endpgm
L_tail:
    s_waitcnt lgkmcnt(0)
    s_load_dwordx2 s[44:45], s[0:1], 0
    s_load_dwordx2 s[40:41], s[0:1], 40
    s_load_dwordx2 s[8:9], s[0:1], 48
    s_load_dwordx2 s[12:13], s[0:1], 24
    s_load_dwordx2 s[24:25], s[0:1], 32
    s_mov_b32 s46, 24576
    s_mov_b32 s47, 0x20000
    s_mov_b32 s42, 294912
    s_mov_b32 s43, 0x20000
    s_mov_b32 s10, 589824
    s_mov_b32 s11, 0x20000
    s_mov_b32 s14, 294912
    s_mov_b32 s15, 0x20000
    s_mov_b32 s26, 294912
    s_mov_b32 s27, 0x20000
    s_and_b32 s4, s2, 1
    s_lshr_b32 s5, s2, 1
    s_mul_i32 s35, s4, 12288
    s_lshl_b32 s30, s3, 1
    s_lshr_b32 s30, 0x78, s30
    s_and_b32 s30, s30, 3
    s_mul_i32 s31, s3, 3072
    v_add_u32 v8, 0, v0
    v_mul_u32_u24 v9, 1366, v8
    v_lshrrev_b32 v9, 16, v9
    v_mul_u32_u24 v10, 48, v9
    v_sub_u32 v8, v8, v10
    v_lshl_or_b32 v10, v9, 2, s30
    v_xor_b32 v8, v8, v10
    v_mul_u32_u24 v9, 768, v9
    v_lshl_add_u32 v8, v8, 4, v9
    v_add_u32 v4, s31, v8
    v_add_u32 v8, 64, v0
    v_mul_u32_u24 v9, 1366, v8
    v_lshrrev_b32 v9, 16, v9
    v_mul_u32_u24 v10, 48, v9
    v_sub_u32 v8, v8, v10
    v_lshl_or_b32 v10, v9, 2, s30
    v_xor_b32 v8, v8, v10
    v_mul_u32_u24 v9, 768, v9
    v_lshl_add_u32 v8, v8, 4, v9
    v_add_u32 v5, s31, v8
    v_add_u32 v8, 128, v0
    v_mul_u32_u24 v9, 1366, v8
    v_lshrrev_b32 v9, 16, v9
    v_mul_u32_u24 v10, 48, v9
    v_sub_u32 v8, v8, v10
    v_lshl_or_b32 v10, v9, 2, s30
    v_xor_b32 v8, v8, v10
    v_mul_u32_u24 v9, 768, v9
    v_lshl_add_u32 v8, v8, 4, v9
    v_add_u32 v6, s31, v8
    v_lshrrev_b32 v7, 1, v0
    v_bfe_u32 v8, v0, 4, 1
    v_lshlrev_b32 v8, 2, v8
    v_xor_b32 v7, v7, v8
    v_mul_u32_u24 v7, 768, v7
    v_and_b32 v8, 1, v0
    v_lshl_add_u32 v7, v8, 4, v7
    s_lshl_b32 s36, s5, 5
    s_mul_i32 s30, s3, 73728
    s_add_u32 s36, s36, s30
    s_waitcnt lgkmcnt(0)
    s_mul_i32 s30, s3, 3072
    s_add_u32 m0, s30, 49152
    s_nop 0
    buffer_load_dwordx4 v4, s[44:47], s35 offen lds
    s_add_u32 m0, m0, 1024
    s_nop 0
    buffer_load_dwordx4 v5, s[44:47], s35 offen lds
    s_add_u32 m0, m0, 1024
    s_nop 0
    buffer_load_dwordx4 v6, s[44:47], s35 offen lds
    s_add_u32 m0, m0, 10240
    s_nop 0
    buffer_load_dwordx4 v7, s[40:43], s36 offen lds
    s_add_u32 m0, m0, 1024
    s_add_u32 s36, s36, 24576
    s_nop 0
    buffer_load_dwordx4 v7, s[40:43], s36 offen lds
    s_add_u32 m0, m0, 1024
    s_add_u32 s36, s36, 24576
    s_nop 0
    buffer_load_dwordx4 v7, s[40:43], s36 offen lds
    s_add_u32 m0, m0, 1024
    s_add_u32 s36, s36, 24576
    s_mul_i32 s32, s5, 12288
    s_lshl_b32 s33, s32, 1
    v_add_u32 v8, 0, v0
    v_mul_u32_u24 v8, 1366, v8
    v_lshrrev_b32 v8, 16, v8
    v_mul_u32_u24 v8, 768, v8
    v_add3_u32 v124, v8, v4, s31
    v_add_u32 v8, 64, v0
    v_mul_u32_u24 v8, 1366, v8
    v_lshrrev_b32 v8, 16, v8
    v_mul_u32_u24 v8, 768, v8
    v_add3_u32 v125, v8, v5, s31
    v_add_u32 v8, 128, v0
    v_mul_u32_u24 v8, 1366, v8
    v_lshrrev_b32 v8, 16, v8
    v_mul_u32_u24 v8, 768, v8
    v_add3_u32 v126, v8, v6, s31
    s_mov_b32 s18, 452984832
    s_mov_b32 s19, 0x20000
    s_mov_b32 s22, 256
    s_mov_b32 s23, 0x20000
    s_mov_b32 s61, 2000000
    s_mul_i32 s30, s3, 3072
    s_add_u32 m0, s30, 12288
    s_nop 0
    buffer_load_dwordx4 v124, s[8:11], s33 offen lds
    s_add_u32 m0, m0, 1024
    s_nop 0
    buffer_load_dwordx4 v125, s[8:11], s33 offen lds
    s_add_u32 m0, m0, 1024
    s_nop 0
    buffer_load_dwordx4 v126, s[8:11], s33 offen lds
    s_add_u32 m0, m0, 10240
    v_mov_b64 v[136:137], v[4:5]
    v_mov_b32 v138, v6
    s_mul_i32 s30, s3, 3072
    s_add_u32 m0, s30, 24576
    s_nop 0
    buffer_load_dwordx4 v136, s[12:15], s32 offen lds
    s_add_u32 m0, m0, 1024
    s_nop 0
    buffer_load_dwordx4 v137, s[12:15], s32 offen lds
    s_add_u32 m0, m0, 1024
    s_nop 0
    buffer_load_dwordx4 v138, s[12:15], s32 offen lds
    s_add_u32 m0, m0, 10240
    s_mul_i32 s30, s3, 3072
    s_add_u32 m0, s30, 36864
    s_nop 0
    buffer_load_dwordx4 v136, s[24:27], s32 offen lds
    s_add_u32 m0, m0, 1024
    s_nop 0
    buffer_load_dwordx4 v137, s[24:27], s32 offen lds
    s_add_u32 m0, m0, 1024
    s_nop 0
    buffer_load_dwordx4 v138, s[24:27], s32 offen lds
    s_add_u32 m0, m0, 10240
    v_lshlrev_b32 v12, 4, v0
    v_and_b32 v2, 15, v0
    v_lshrrev_b32 v3, 4, v0
    v_lshrrev_b32 v14, 1, v3
    v_lshlrev_b32 v14, 8, v14
    v_lshl_add_u32 v14, v2, 4, v14
    v_and_b32 v8, 15, v0
    v_lshrrev_b32 v9, 2, v8
    v_lshlrev_b32 v9, 1, v9
    s_mov_b32 s30, 0x78
    v_lshrrev_b32 v9, v9, s30
    v_and_b32 v9, 3, v9
    v_and_b32 v10, 3, v0
    v_lshl_or_b32 v9, v10, 2, v9
    v_lshrrev_b32 v10, 4, v0
    v_xor_b32 v9, v9, v10
    v_mul_u32_u24 v8, 768, v8
    v_lshl_add_u32 v8, v9, 4, v8
    v_add_u32 v120, 12288, v8
    v_xor_b32 v121, 64, v120
    v_xor_b32 v122, 128, v120
    v_xor_b32 v123, 192, v120
    s_mul_i32 s30, s3, 192
    s_add_u32 s30, s30, 0
    s_and_b32 s31, s30, 0xc0
    s_and_b32 s30, s30, 0x300
    v_xor_b32 v121, s31, v120
    v_add_u32 v121, s30, v121
    s_mul_i32 s30, s3, 192
    s_add_u32 s30, s30, 64
    s_and_b32 s31, s30, 0xc0
    s_and_b32 s30, s30, 0x300
    v_xor_b32 v122, s31, v120
    v_add_u32 v122, s30, v122
    s_mul_i32 s30, s3, 192
    s_add_u32 s30, s30, 128
    s_and_b32 s31, s30, 0xc0
    s_and_b32 s30, s30, 0x300
    v_xor_b32 v123, s31, v120
    v_add_u32 v123, s30, v123
    v_lshrrev_b32 v8, 4, v0
    v_lshlrev_b32 v6, 8, v8
    v_and_b32 v8, 1, v8
    v_lshl_add_u32 v6, v8, 7, v6
    v_and_b32 v8, 15, v0
    v_lshl_add_u32 v6, v8, 3, v6
    v_xor_b32 v7, 128, v6
    s_mul_i32 s30, s3, 3072
    s_add_u32 s36, s35, s30
    s_add_u32 s37, s36, 24576
    s_add_u32 s36, s36, 0
    s_add_u32 s30, s30, 61440
    v_add_u32 v6, s30, v6
    v_add_u32 v7, s30, v7
    s_lshl_b32 s38, s5, 9
    s_add_u32 s38, s38, s35
    s_add_u32 s38, s38, 0
    s_lshl_b32 s30, s3, 10
    v_add_u32 v9, s30, v12
    v_add_u32 v13, 73728, v9
    s_mov_b32 s30, 0x3f803f80
    v_mov_b64 v[140:141], 0
    v_mov_b32 v124, s30
    v_mov_b32 v125, s30
    v_mov_b32 v126, s30
    v_mov_b32 v127, s30
    s_waitcnt vmcnt(9)
    s_barrier
    s_lshl_b32 s60, s4, 7
    s_mov_b64 exec, 1
    buffer_load_dwordx4 v[132:135], off, s[20:23], s60 sc1
    s_mov_b64 exec, -1
    ds_read_b128 v[64:67], v121 offset:36864
    ds_read_b128 v[68:71], v122 offset:36864
    ds_read_b128 v[72:75], v123 offset:36864
    ds_read_b64_tr_b16 v[76:77], v6 offset:0
    ds_read_b64_tr_b16 v[78:79], v7 offset:0
    ds_read_b64_tr_b16 v[80:81], v6 offset:1024
    ds_read_b64_tr_b16 v[82:83], v7 offset:1024
    ds_read_b64_tr_b16 v[84:85], v6 offset:2048
    ds_read_b64_tr_b16 v[86:87], v7 offset:2048
    s_waitcnt lgkmcnt(6)
    v_dot2c_f32_bf16 v140, v64, v124
    v_dot2c_f32_bf16 v141, v64, v64
    v_dot2c_f32_bf16 v140, v65, v124
    v_dot2c_f32_bf16 v141, v65, v65
    v_dot2c_f32_bf16 v140, v66, v124
    v_dot2c_f32_bf16 v141, v66, v66
    v_dot2c_f32_bf16 v140, v67, v124
    v_dot2c_f32_bf16 v141, v67, v67
    v_dot2c_f32_bf16 v140, v68, v124
    v_dot2c_f32_bf16 v141, v68, v68
    v_dot2c_f32_bf16 v140, v69, v124
    v_dot2c_f32_bf16 v141, v69, v69
    v_dot2c_f32_bf16 v140, v70, v124
    v_dot2c_f32_bf16 v141, v70, v70
    v_dot2c_f32_bf16 v140, v71, v124
    v_dot2c_f32_bf16 v141, v71, v71
    v_dot2c_f32_bf16 v140, v72, v124
    v_dot2c_f32_bf16 v141, v72, v72
    v_dot2c_f32_bf16 v140, v73, v124
    v_dot2c_f32_bf16 v141, v73, v73
    v_dot2c_f32_bf16 v140, v74, v124
    v_dot2c_f32_bf16 v141, v74, v74
    v_dot2c_f32_bf16 v140, v75, v124
    v_dot2c_f32_bf16 v141, v75, v75
    s_waitcnt lgkmcnt(0)
    v_mfma_f32_16x16x32_bf16 v[112:115], v[76:79], v[64:67], 0
    v_mfma_f32_16x16x32_bf16 v[116:119], v[76:79], v[124:127], 0
    v_mfma_f32_16x16x32_bf16 v[112:115], v[80:83], v[68:71], v[112:115]
    v_mfma_f32_16x16x32_bf16 v[116:119], v[80:83], v[124:127], v[116:119]
    v_mfma_f32_16x16x32_bf16 v[112:115], v[84:87], v[72:75], v[112:115]
    v_mfma_f32_16x16x32_bf16 v[116:119], v[84:87], v[124:127], v[116:119]
    v_mov_b64 v[142:143], v[140:141]
    s_nop 1
    v_permlane16_swap_b32 v140, v142
    v_permlane16_swap_b32 v141, v143
    v_add_f32 v140, v140, v142
    v_add_f32 v141, v141, v143
    v_mov_b64 v[142:143], v[140:141]
    s_nop 1
    v_permlane32_swap_b32 v140, v142
    v_permlane32_swap_b32 v141, v143
    v_add_f32 v140, v140, v142
    v_add_f32 v141, v141, v143
    ds_write_b128 v13, v[112:115]
    ds_write_b128 v13, v[116:119] offset:4096
    ds_write_b64 v13, v[140:141] offset:8192
    s_waitcnt vmcnt(1) lgkmcnt(0)
    s_barrier
    s_cmp_lg_u32 s3, 0
    s_cbranch_scc1 L_p2_17
    ds_read_b64 v[144:145], v13 offset:9216
    ds_read_b64 v[146:147], v13 offset:10240
    ds_read_b64 v[148:149], v13 offset:11264
    ds_read_b128 v[72:75], v13 offset:1024
    ds_read_b128 v[76:79], v13 offset:5120
    ds_read_b128 v[80:83], v13 offset:2048
    ds_read_b128 v[84:87], v13 offset:6144
    ds_read_b128 v[88:91], v13 offset:3072
    ds_read_b128 v[92:95], v13 offset:7168
L_p2_17:
    s_waitcnt vmcnt(0)
L_ew_18:
    v_readfirstlane_b32 s30, v132
    v_readfirstlane_b32 s31, v133
    s_and_b32 s30, s30, s31
    s_cmp_lg_u32 s30, 0
    s_cbranch_scc0 L_ew_18_r
L_ew_18_d:
    v_readfirstlane_b32 s56, v134
    v_readfirstlane_b32 s57, v135
    s_getreg_b32 s30, hwreg(HW_REG_XCC_ID, 0, 4)
    s_lshl_b32 s30, s30, 3
    s_lshr_b64 s[56:57], s[56:57], s30
    s_and_b32 s56, s56, 0xff
    s_cmp_eq_u32 s56, 24
    s_cselect_b32 s59, 1, 0
    s_cmp_lt_u32 s30, 64
    s_cselect_b32 s59, s59, 0
    s_cmp_lg_u32 s3, 0
    s_cbranch_scc1 L_p2_17_b
    s_waitcnt lgkmcnt(6)
    v_pk_add_f32 v[140:141], v[140:141], v[144:145]
    v_pk_add_f32 v[140:141], v[140:141], v[146:147]
    v_pk_add_f32 v[140:141], v[140:141], v[148:149]
    v_mul_f32 v140, 0x3b2aaaab, v140
    v_mul_f32 v141, 0x3b2aaaab, v141
    v_fma_f32 v141, -v140, v140, v141
    v_max_f32 v141, 0, v141
    v_add_f32 v141, 0x3727c5ac, v141
    v_rsq_f32 v141, v141
    s_waitcnt lgkmcnt(4)
    v_pk_add_f32 v[112:113], v[112:113], v[72:73]
    v_pk_add_f32 v[114:115], v[114:115], v[74:75]
    v_pk_add_f32 v[116:117], v[116:117], v[76:77]
    v_pk_add_f32 v[118:119], v[118:119], v[78:79]
    s_waitcnt lgkmcnt(2)
    v_pk_add_f32 v[112:113], v[112:113], v[80:81]
    v_pk_add_f32 v[114:115], v[114:115], v[82:83]
    v_pk_add_f32 v[116:117], v[116:117], v[84:85]
    v_pk_add_f32 v[118:119], v[118:119], v[86:87]
    s_waitcnt lgkmcnt(0)
    v_pk_add_f32 v[112:113], v[112:113], v[88:89]
    v_pk_add_f32 v[114:115], v[114:115], v[90:91]
    v_pk_add_f32 v[116:117], v[116:117], v[92:93]
    v_pk_add_f32 v[118:119], v[118:119], v[94:95]
    v_fma_f32 v112, -v140, v116, v112
    v_fma_f32 v113, -v140, v117, v113
    v_fma_f32 v114, -v140, v118, v114
    v_fma_f32 v115, -v140, v119, v115
    v_mul_f32 v112, v141, v112
    v_mul_f32 v113, v141, v113
    v_mul_f32 v114, v141, v114
    v_mul_f32 v115, v141, v115
    v_cvt_pk_bf16_f32 v116, v112, v113
    v_cvt_pk_bf16_f32 v117, v114, v115
    v_min_u32 v116, -2, v116
    v_min_u32 v117, -2, v117
    s_nop 0
    v_permlane16_swap_b32 v116, v118
    v_permlane16_swap_b32 v117, v119
    s_mov_b32 exec_lo, 0xffff
    s_mov_b32 exec_hi, 0xffff
    s_cmp_lg_u32 s59, 0
    s_cbranch_scc0 L_hs_19
    buffer_store_dwordx4 v[116:119], v14, s[16:19], s38 offen
L_hs_19_b:
    s_mov_b64 exec, -1
L_p2_17_b:
    s_add_u32 s38, s38, 24576
    v_lshlrev_b32 v10, 7, v0
    s_mov_b64 exec, 15
    buffer_load_dword v11, v10, s[16:19], s38 offen sc1
    s_mov_b64 exec, -1
    ds_read_b128 v[16:19], v121 offset:0
    ds_read_b128 v[20:23], v122 offset:0
    ds_read_b128 v[24:27], v123 offset:0
    ds_read_b128 v[28:31], v121 offset:12288
    ds_read_b128 v[32:35], v122 offset:12288
    ds_read_b128 v[36:39], v123 offset:12288
    ds_read_b128 v[40:43], v121 offset:24576
    ds_read_b128 v[44:47], v122 offset:24576
    ds_read_b128 v[48:51], v123 offset:24576
L_g_20:
    buffer_load_dwordx4 v[64:67], v12, s[16:19], s36 offen offset:0 sc1
    buffer_load_dwordx4 v[68:71], v12, s[16:19], s36 offen offset:1024 sc1
    buffer_load_dwordx4 v[72:75], v12, s[16:19], s36 offen offset:2048 sc1
    s_sub_u32 s61, s61, 1
    s_cmp_gt_i32 s61, 0
    s_cselect_b64 s[62:63], -1, 0
    s_waitcnt vmcnt(2)
    v_max_u32 v10, v64, v65
    v_max3_u32 v10, v10, v66, v67
    s_waitcnt vmcnt(1)
    v_max3_u32 v10, v10, v68, v69
    v_max3_u32 v10, v10, v70, v71
    s_waitcnt vmcnt(0)
    v_max3_u32 v10, v10, v72, v73
    v_max3_u32 v10, v10, v74, v75
    v_cmp_eq_u32 vcc, -1, v10
    s_and_b64 vcc, vcc, s[62:63]
    s_cbranch_scc1 L_g_20
    s_waitcnt lgkmcnt(0)
    v_mfma_f32_16x16x32_bf16 v[112:115], v[16:19], v[64:67], 0
    v_mfma_f32_16x16x32_bf16 v[112:115], v[20:23], v[68:71], v[112:115]
    v_mfma_f32_16x16x32_bf16 v[112:115], v[24:27], v[72:75], v[112:115]
    s_nop 7
    ds_write_b128 v9, v[112:115]
    s_waitcnt lgkmcnt(0)
    s_barrier
    s_cmp_lg_u32 s3, 0
    s_cbranch_scc1 L_p3_21
    ds_read_b128 v[68:71], v12 offset:1024
    ds_read_b128 v[72:75], v12 offset:2048
    ds_read_b128 v[76:79], v12 offset:3072
    s_waitcnt lgkmcnt(2)
    v_add_f32 v112, v112, v68
    v_add_f32 v113, v113, v69
    v_add_f32 v114, v114, v70
    v_add_f32 v115, v115, v71
    s_waitcnt lgkmcnt(1)
    v_add_f32 v112, v112, v72
    v_add_f32 v113, v113, v73
    v_add_f32 v114, v114, v74
    v_add_f32 v115, v115, v75
    s_waitcnt lgkmcnt(0)
    v_add_f32 v112, v112, v76
    v_add_f32 v113, v113, v77
    v_add_f32 v114, v114, v78
    v_add_f32 v115, v115, v79
    v_cvt_pk_bf16_f32 v116, v112, v113
    v_cvt_pk_bf16_f32 v117, v114, v115
    v_min_u32 v116, -2, v116
    v_min_u32 v117, -2, v117
    s_nop 0
    v_permlane16_swap_b32 v116, v118
    v_permlane16_swap_b32 v117, v119
    s_mov_b32 exec_lo, 0xffff
    s_mov_b32 exec_hi, 0xffff
    s_cmp_lg_u32 s59, 0
    s_cbranch_scc0 L_hs_23
    buffer_store_dwordx4 v[116:119], v14, s[16:19], s38 offen
L_hs_23_b:
    s_mov_b64 exec, -1
L_p3_21:
L_g_24:
    buffer_load_dwordx4 v[64:67], v12, s[16:19], s37 offen offset:0 sc1
    buffer_load_dwordx4 v[68:71], v12, s[16:19], s37 offen offset:1024 sc1
    buffer_load_dwordx4 v[72:75], v12, s[16:19], s37 offen offset:2048 sc1
    s_sub_u32 s61, s61, 1
    s_cmp_gt_i32 s61, 0
    s_cselect_b64 s[62:63], -1, 0
    s_waitcnt vmcnt(2)
    v_max_u32 v10, v64, v65
    v_max3_u32 v10, v10, v66, v67
    s_waitcnt vmcnt(1)
    v_max3_u32 v10, v10, v68, v69
    v_max3_u32 v10, v10, v70, v71
    s_waitcnt vmcnt(0)
    v_max3_u32 v10, v10, v72, v73
    v_max3_u32 v10, v10, v74, v75
    v_cmp_eq_u32 vcc, -1, v10
    s_and_b64 vcc, vcc, s[62:63]
    s_cbranch_scc1 L_g_24
    s_waitcnt lgkmcnt(0)
    v_mfma_f32_16x16x32_bf16 v[112:115], v[28:31], v[64:67], 0
    v_mfma_f32_16x16x32_bf16 v[116:119], v[40:43], v[64:67], 0
    v_mfma_f32_16x16x32_bf16 v[112:115], v[32:35], v[68:71], v[112:115]
    v_mfma_f32_16x16x32_bf16 v[116:119], v[44:47], v[68:71], v[116:119]
    v_mfma_f32_16x16x32_bf16 v[112:115], v[36:39], v[72:75], v[112:115]
    v_mfma_f32_16x16x32_bf16 v[116:119], v[48:51], v[72:75], v[116:119]
    s_lshl_b32 s38, s5, 9
    s_mul_i32 s31, s3, 12288
    s_add_u32 s38, s38, s31
    s_lshl_b32 s31, s35, 1
    s_add_u32 s38, s38, s31
    s_add_u32 s38, s38, 36864
    s_lshl_b32 s30, s3, 12
    v_add_u32 v8, s30, v12
    ds_write_b128 v9, v[112:115] offset:4096
    ds_write_b128 v9, v[116:119] offset:8192
    s_waitcnt lgkmcnt(0)
    s_barrier
    s_add_u32 s30, s3, 1
    s_and_b32 s30, s30, 2
    s_cbranch_scc0 L_b2_25
    ds_read_b128 v[64:67], v8 offset:0
    ds_read_b128 v[68:71], v8 offset:1024
    ds_read_b128 v[72:75], v8 offset:2048
    ds_read_b128 v[76:79], v8 offset:3072
    s_waitcnt lgkmcnt(2)
    v_add_f32 v112, v64, v68
    v_add_f32 v113, v65, v69
    v_add_f32 v114, v66, v70
    v_add_f32 v115, v67, v71
    s_waitcnt lgkmcnt(0)
    v_add_f32 v72, v72, v76
    v_add_f32 v73, v73, v77
    v_add_f32 v74, v74, v78
    v_add_f32 v75, v75, v79
    v_add_f32 v112, v112, v72
    v_add_f32 v113, v113, v73
    v_add_f32 v114, v114, v74
    v_add_f32 v115, v115, v75
    v_mul_f32 v112, 0x3d96c740, v112
    v_mul_f32 v113, 0x3d96c740, v113
    v_mul_f32 v114, 0x3d96c740, v114
    v_mul_f32 v115, 0x3d96c740, v115
    v_cvt_pk_bf16_f32 v116, v112, v113
    v_cvt_pk_bf16_f32 v117, v114, v115
    v_min_u32 v116, -2, v116
    v_min_u32 v117, -2, v117
    s_nop 0
    v_permlane16_swap_b32 v116, v118
    v_permlane16_swap_b32 v117, v119
    s_mov_b32 exec_lo, 0xffff
    s_mov_b32 exec_hi, 0xffff
    buffer_store_dwordx4 v[116:119], v14, s[16:19], s38 offen sc1
    s_mov_b64 exec, -1
L_b2_25:
    s_waitcnt vmcnt(0)
    s_barrier
    s_load_dwordx2 s[40:41], s[0:1], 0
    s_load_dwordx2 s[44:45], s[0:1], 80
    s_load_dwordx2 s[52:53], s[0:1], 64
    s_load_dwordx2 s[96:97], s[0:1], 72
    s_load_dwordx2 s[36:37], s[0:1], 56
    s_mov_b32 s42, 24576
    s_mov_b32 s43, 0x20000
    s_mov_b32 s46, 24576
    s_mov_b32 s47, 0x20000
    s_mov_b32 s54, 1179648
    s_mov_b32 s55, 0x20000
    s_mov_b32 s98, 1179648
    s_mov_b32 s99, 0x20000
    s_mov_b32 s38, 294912
    s_mov_b32 s39, 0x20000
    s_lshl_b32 s30, s5, 2
    s_add_u32 s30, s30, s3
    s_mul_i32 s30, s30, 24
    v_add_u32 v4, s30, v0
    v_mul_u32_u24 v5, 0xaaab, v4
    v_lshrrev_b32 v5, 18, v5
    v_mad_u32_u24 v5, v5, 6, v4
    v_lshlrev_b32 v4, 7, v4
    v_lshlrev_b32 v5, 7, v5
    s_mov_b64 exec, 0xffffff
    s_waitcnt lgkmcnt(0)
    buffer_load_dword v6, v4, s[36:39], 0 offen
    buffer_load_dword v6, v5, s[8:11], 0 offen offset:768
    s_mov_b64 exec, -1
    v_lshrrev_b32 v126, 1, v0
    v_bfe_u32 v10, v0, 4, 1
    v_lshlrev_b32 v10, 2, v10
    v_xor_b32 v126, v126, v10
    v_mul_u32_u24 v126, 768, v126
    v_and_b32 v10, 1, v0
    v_lshl_add_u32 v126, v10, 4, v126
    v_mul_u32_u24 v15, 768, v2
    v_lshl_add_u32 v15, v3, 3, v15
    s_lshl_b32 s48, s5, 5
    s_add_u32 s48, s48, s35
    buffer_load_dwordx2 v[252:253], v15, s[40:43], s48 offen
    s_lshl_b32 s32, s5, 5
    s_mul_i32 s30, s3, 73728
    s_add_u32 s32, s32, s30
    s_mul_i32 s30, s3, 3072
    s_add_u32 m0, s30, 147456
    s_waitcnt vmcnt(0)
    buffer_load_dwordx4 v126, s[36:39], s32 offen lds
    s_add_u32 m0, m0, 1024
    s_add_u32 s32, s32, 24576
    buffer_load_dwordx4 v126, s[36:39], s32 offen lds
    s_add_u32 m0, m0, 1024
    s_add_u32 s32, s32, 24576
    buffer_load_dwordx4 v126, s[36:39], s32 offen lds
    s_add_u32 m0, m0, 1024
    s_add_u32 s32, s32, 24576
    v_lshrrev_b32 v10, 4, v0
    v_lshlrev_b32 v124, 8, v10
    v_and_b32 v10, 1, v10
    v_lshl_add_u32 v124, v10, 7, v124
    v_and_b32 v10, 15, v0
    v_lshl_add_u32 v124, v10, 3, v124
    v_xor_b32 v125, 128, v124
    v_add_u32 v4, 147456, v124
    v_add_u32 v5, 147456, v125
    s_waitcnt vmcnt(0)
    s_barrier
    ds_read_b64_tr_b16 v[64:65], v4 offset:0
    ds_read_b64_tr_b16 v[66:67], v5 offset:0
    ds_read_b64_tr_b16 v[68:69], v4 offset:1024
    ds_read_b64_tr_b16 v[70:71], v5 offset:1024
    ds_read_b64_tr_b16 v[72:73], v4 offset:2048
    ds_read_b64_tr_b16 v[74:75], v5 offset:2048
    ds_read_b64_tr_b16 v[76:77], v4 offset:3072
    ds_read_b64_tr_b16 v[78:79], v5 offset:3072
    ds_read_b64_tr_b16 v[80:81], v4 offset:4096
    ds_read_b64_tr_b16 v[82:83], v5 offset:4096
    ds_read_b64_tr_b16 v[84:85], v4 offset:5120
    ds_read_b64_tr_b16 v[86:87], v5 offset:5120
    s_waitcnt lgkmcnt(0)
    ds_read_b64_tr_b16 v[88:89], v4 offset:6144
    ds_read_b64_tr_b16 v[90:91], v5 offset:6144
    ds_read_b64_tr_b16 v[92:93], v4 offset:7168
    ds_read_b64_tr_b16 v[94:95], v5 offset:7168
    ds_read_b64_tr_b16 v[96:97], v4 offset:8192
    ds_read_b64_tr_b16 v[98:99], v5 offset:8192
    ds_read_b64_tr_b16 v[100:101], v4 offset:9216
    ds_read_b64_tr_b16 v[102:103], v5 offset:9216
    ds_read_b64_tr_b16 v[104:105], v4 offset:10240
    ds_read_b64_tr_b16 v[106:107], v5 offset:10240
    ds_read_b64_tr_b16 v[108:109], v4 offset:11264
    ds_read_b64_tr_b16 v[110:111], v5 offset:11264
    s_waitcnt lgkmcnt(0)
    s_barrier
    s_mul_i32 s34, s3, 36864
    s_add_u32 s49, s34, 36864
    s_mul_i32 s32, s3, 147456
    s_add_u32 s32, s32, 768
    v_add_u32 v8, 0, v0
    v_mul_u32_u24 v10, 1366, v8
    v_lshrrev_b32 v10, 16, v10
    v_mul_u32_u24 v11, 48, v10
    v_sub_u32 v8, v8, v11
    v_lshlrev_b32 v11, 2, v10
    v_xor_b32 v8, v8, v11
    v_mul_u32_u24 v10, 1536, v10
    v_lshl_add_u32 v4, v8, 4, v10
    v_add_u32 v8, 64, v0
    v_mul_u32_u24 v10, 1366, v8
    v_lshrrev_b32 v10, 16, v10
    v_mul_u32_u24 v11, 48, v10
    v_sub_u32 v8, v8, v11
    v_lshlrev_b32 v11, 2, v10
    v_xor_b32 v8, v8, v11
    v_mul_u32_u24 v10, 1536, v10
    v_lshl_add_u32 v5, v8, 4, v10
    v_add_u32 v8, 128, v0
    v_mul_u32_u24 v10, 1366, v8
    v_lshrrev_b32 v10, 16, v10
    v_mul_u32_u24 v11, 48, v10
    v_sub_u32 v8, v8, v11
    v_lshlrev_b32 v11, 2, v10
    v_xor_b32 v8, v8, v11
    v_mul_u32_u24 v10, 1536, v10
    v_lshl_add_u32 v6, v8, 4, v10
    v_and_b32 v8, 15, v0
    v_lshrrev_b32 v10, 2, v8
    v_lshlrev_b32 v10, 1, v10
    s_mov_b32 s30, 0x78
    v_lshrrev_b32 v10, v10, s30
    v_and_b32 v10, 3, v10
    v_and_b32 v11, 3, v0
    v_lshl_or_b32 v10, v11, 2, v10
    v_lshrrev_b32 v11, 4, v0
    v_xor_b32 v10, v10, v11
    v_mul_u32_u24 v8, 768, v8
    v_lshl_add_u32 v8, v10, 4, v8
    v_add_u32 v120, 0, v8
    v_xor_b32 v121, 64, v120
    v_xor_b32 v122, 128, v120
    v_xor_b32 v123, 192, v120
    v_add_u32 v120, s34, v120
    v_add_u32 v121, s34, v121
    v_add_u32 v122, s34, v122
    v_add_u32 v123, s34, v123
    s_mov_b32 s50, s34
    s_mov_b32 s51, 0
    s_mov_b32 s31, -3
    s_mov_b32 s29, 0
    s_branch L_ys_i
L_ys:
    s_waitcnt vmcnt(24)
    s_cmp_lt_i32 s31, 4
    s_cbranch_scc1 L_ys_w
    s_waitcnt vmcnt(0)
L_ys_w:
    ds_read_b128 v[16:19], v120 offset:0
    ds_read_b128 v[20:23], v121 offset:0
    ds_read_b128 v[24:27], v122 offset:0
    ds_read_b128 v[28:31], v123 offset:0
    ds_read_b128 v[32:35], v120 offset:256
    ds_read_b128 v[36:39], v121 offset:256
    ds_read_b128 v[40:43], v122 offset:256
    ds_read_b128 v[44:47], v123 offset:256
    ds_read_b128 v[48:51], v120 offset:512
    ds_read_b128 v[52:55], v121 offset:512
    ds_read_b128 v[56:59], v122 offset:512
    ds_read_b128 v[60:63], v123 offset:512
    s_add_u32 s29, s29, 1
    s_cmp_eq_u32 s29, 3
    s_cselect_b32 s29, 0, s29
    s_cselect_b32 s30, -2, 1
    s_mulk_i32 s30, 12288
    v_mov_b64 v[224:225], v[226:227]
    v_mov_b64 v[226:227], v[228:229]
    v_mov_b64 v[228:229], v[230:231]
    v_mov_b64 v[230:231], v[232:233]
    v_mov_b64 v[232:233], v[234:235]
    v_mov_b64 v[234:235], v[236:237]
    v_mov_b64 v[236:237], v[238:239]
    v_mov_b64 v[238:239], v[240:241]
    v_mov_b64 v[240:241], v[242:243]
    v_mov_b64 v[242:243], v[244:245]
    v_mov_b64 v[244:245], v[246:247]
    s_waitcnt lgkmcnt(11)
    v_mfma_f32_16x16x32_bf16 v[112:115], v[16:19], v[64:67], 0
    s_waitcnt lgkmcnt(10)
    v_mfma_f32_16x16x32_bf16 v[112:115], v[20:23], v[68:71], v[112:115]
    s_waitcnt lgkmcnt(9)
    v_mfma_f32_16x16x32_bf16 v[112:115], v[24:27], v[72:75], v[112:115]
    s_waitcnt lgkmcnt(8)
    v_mfma_f32_16x16x32_bf16 v[112:115], v[28:31], v[76:79], v[112:115]
    s_waitcnt lgkmcnt(7)
    v_mfma_f32_16x16x32_bf16 v[112:115], v[32:35], v[80:83], v[112:115]
    s_waitcnt lgkmcnt(6)
    v_mfma_f32_16x16x32_bf16 v[112:115], v[36:39], v[84:87], v[112:115]
    s_waitcnt lgkmcnt(5)
    v_mfma_f32_16x16x32_bf16 v[112:115], v[40:43], v[88:91], v[112:115]
    s_waitcnt lgkmcnt(4)
    v_mfma_f32_16x16x32_bf16 v[112:115], v[44:47], v[92:95], v[112:115]
    s_waitcnt lgkmcnt(3)
    v_mfma_f32_16x16x32_bf16 v[112:115], v[48:51], v[96:99], v[112:115]
    s_waitcnt lgkmcnt(2)
    v_mfma_f32_16x16x32_bf16 v[112:115], v[52:55], v[100:103], v[112:115]
    s_waitcnt lgkmcnt(1)
    v_mfma_f32_16x16x32_bf16 v[112:115], v[56:59], v[104:107], v[112:115]
    s_waitcnt lgkmcnt(0)
    v_mfma_f32_16x16x32_bf16 v[112:115], v[60:63], v[108:111], v[112:115]
    v_add_u32 v120, s30, v120
    v_add_u32 v121, s30, v121
    v_add_u32 v122, s30, v122
    v_add_u32 v123, s30, v123
    s_nop 3
    v_cvt_pk_bf16_f32 v246, v112, v113
    v_cvt_pk_bf16_f32 v247, v114, v115
    s_cmp_ge_i32 s31, 3
    s_cbranch_scc1 L_ys_n
L_ys_i:
    s_mov_b32 m0, s50
    s_mov_b32 s33, s32
    v_xor_b32 v8, 0, v4
    buffer_load_dwordx4 v8, s[8:11], s33 offen lds
    s_add_u32 m0, m0, 1024
    v_xor_b32 v8, 0, v5
    buffer_load_dwordx4 v8, s[8:11], s33 offen lds
    s_add_u32 m0, m0, 1024
    v_xor_b32 v8, 0, v6
    buffer_load_dwordx4 v8, s[8:11], s33 offen lds
    s_add_u32 m0, m0, 1024
    s_add_u32 s33, s33, 12288
    v_xor_b32 v8, 32, v4
    buffer_load_dwordx4 v8, s[8:11], s33 offen lds
    s_add_u32 m0, m0, 1024
    v_xor_b32 v8, 32, v5
    buffer_load_dwordx4 v8, s[8:11], s33 offen lds
    s_add_u32 m0, m0, 1024
    v_xor_b32 v8, 32, v6
    buffer_load_dwordx4 v8, s[8:11], s33 offen lds
    s_add_u32 m0, m0, 1024
    s_add_u32 s33, s33, 12288
    v_xor_b32 v8, 48, v4
    buffer_load_dwordx4 v8, s[8:11], s33 offen lds
    s_add_u32 m0, m0, 1024
    v_xor_b32 v8, 48, v5
    buffer_load_dwordx4 v8, s[8:11], s33 offen lds
    s_add_u32 m0, m0, 1024
    v_xor_b32 v8, 48, v6
    buffer_load_dwordx4 v8, s[8:11], s33 offen lds
    s_add_u32 m0, m0, 1024
    s_add_u32 s33, s33, 12288
    v_xor_b32 v8, 16, v4
    buffer_load_dwordx4 v8, s[8:11], s33 offen lds
    s_add_u32 m0, m0, 1024
    v_xor_b32 v8, 16, v5
    buffer_load_dwordx4 v8, s[8:11], s33 offen lds
    s_add_u32 m0, m0, 1024
    v_xor_b32 v8, 16, v6
    buffer_load_dwordx4 v8, s[8:11], s33 offen lds
    s_add_u32 m0, m0, 1024
    s_add_u32 s50, s50, 12288
    s_cmp_eq_u32 s50, s49
    s_cselect_b32 s50, s34, s50
    s_xor_b32 s51, s51, 1
    s_cselect_b32 s30, 4, 28
    s_mul_i32 s30, s30, 1536
    s_add_u32 s32, s32, s30
L_ys_n:
    s_add_u32 s31, s31, 1
    s_cmp_lt_i32 s31, 0
    s_cbranch_scc1 L_ys_i
    s_cmp_lt_i32 s31, 6
    s_cbranch_scc1 L_ys
    s_mul_i32 s30, s3, 3072
    s_add_u32 s30, s30, 147456
    v_add_u32 v8, s30, v12
    v_add_u32 v10, 147456, v12
    ds_write_b128 v8, v[236:239] offset:0
    ds_write_b128 v8, v[240:243] offset:1024
    ds_write_b128 v8, v[244:247] offset:2048
    s_waitcnt lgkmcnt(0)
    s_barrier
    ds_read_b128 v[64:67], v10 offset:0
    ds_read_b128 v[68:71], v10 offset:1024
    ds_read_b128 v[72:75], v10 offset:2048
    ds_read_b128 v[76:79], v10 offset:3072
    ds_read_b128 v[80:83], v10 offset:4096
    ds_read_b128 v[84:87], v10 offset:5120
    ds_read_b128 v[88:91], v10 offset:6144
    ds_read_b128 v[92:95], v10 offset:7168
    ds_read_b128 v[96:99], v10 offset:8192
    ds_read_b128 v[100:103], v10 offset:9216
    ds_read_b128 v[104:107], v10 offset:10240
    ds_read_b128 v[108:111], v10 offset:11264
    s_cmp_ge_u32 s3, 2
    s_cselect_b32 s12, s24, s12
    s_cselect_b32 s13, s25, s13
    s_and_b32 s32, s3, 1
    s_mul_i32 s32, s32, 147456
    s_waitcnt lgkmcnt(0)
    v_add_u32 v8, 0, v0
    v_mul_u32_u24 v10, 1366, v8
    v_lshrrev_b32 v10, 16, v10
    v_mul_u32_u24 v11, 48, v10
    v_sub_u32 v8, v8, v11
    v_lshlrev_b32 v11, 2, v10
    v_xor_b32 v8, v8, v11
    v_mul_u32_u24 v10, 768, v10
    v_lshl_add_u32 v4, v8, 4, v10
    v_add_u32 v8, 64, v0
    v_mul_u32_u24 v10, 1366, v8
    v_lshrrev_b32 v10, 16, v10
    v_mul_u32_u24 v11, 48, v10
    v_sub_u32 v8, v8, v11
    v_lshlrev_b32 v11, 2, v10
    v_xor_b32 v8, v8, v11
    v_mul_u32_u24 v10, 768, v10
    v_lshl_add_u32 v5, v8, 4, v10
    v_add_u32 v8, 128, v0
    v_mul_u32_u24 v10, 1366, v8
    v_lshrrev_b32 v10, 16, v10
    v_mul_u32_u24 v11, 48, v10
    v_sub_u32 v8, v8, v11
    v_lshlrev_b32 v11, 2, v10
    v_xor_b32 v8, v8, v11
    v_mul_u32_u24 v10, 768, v10
    v_lshl_add_u32 v6, v8, 4, v10
    v_and_b32 v8, 15, v0
    v_lshrrev_b32 v10, 2, v8
    v_lshlrev_b32 v10, 1, v10
    s_mov_b32 s30, 0x78
    v_lshrrev_b32 v10, v10, s30
    v_and_b32 v10, 3, v10
    v_and_b32 v11, 3, v0
    v_lshl_or_b32 v10, v11, 2, v10
    v_lshrrev_b32 v11, 4, v0
    v_xor_b32 v10, v10, v11
    v_mul_u32_u24 v8, 768, v8
    v_lshl_add_u32 v8, v10, 4, v8
    v_add_u32 v120, 0, v8
    v_xor_b32 v121, 64, v120
    v_xor_b32 v122, 128, v120
    v_xor_b32 v123, 192, v120
    v_add_u32 v120, s34, v120
    v_add_u32 v121, s34, v121
    v_add_u32 v122, s34, v122
    v_add_u32 v123, s34, v123
    s_mov_b32 s50, s34
    s_mov_b32 s51, 0
    s_mov_b32 s31, -3
    s_mov_b32 s29, 0
    s_branch L_ws_i
L_ws:
    s_waitcnt vmcnt(24)
    s_cmp_lt_i32 s31, 10
    s_cbranch_scc1 L_ws_w
    s_waitcnt vmcnt(0)
L_ws_w:
    ds_read_b128 v[16:19], v120 offset:0
    ds_read_b128 v[20:23], v121 offset:0
    ds_read_b128 v[24:27], v122 offset:0
    ds_read_b128 v[28:31], v123 offset:0
    ds_read_b128 v[32:35], v120 offset:256
    ds_read_b128 v[36:39], v121 offset:256
    ds_read_b128 v[40:43], v122 offset:256
    ds_read_b128 v[44:47], v123 offset:256
    ds_read_b128 v[48:51], v120 offset:512
    ds_read_b128 v[52:55], v121 offset:512
    ds_read_b128 v[56:59], v122 offset:512
    ds_read_b128 v[60:63], v123 offset:512
    s_add_u32 s29, s29, 1
    s_cmp_eq_u32 s29, 3
    s_cselect_b32 s29, 0, s29
    s_cselect_b32 s30, -2, 1
    s_mulk_i32 s30, 12288
    v_mov_b64 v[224:225], v[226:227]
    v_mov_b64 v[226:227], v[228:229]
    v_mov_b64 v[228:229], v[230:231]
    v_mov_b64 v[230:231], v[232:233]
    v_mov_b64 v[232:233], v[234:235]
    v_mov_b64 v[234:235], v[236:237]
    v_mov_b64 v[236:237], v[238:239]
    v_mov_b64 v[238:239], v[240:241]
    v_mov_b64 v[240:241], v[242:243]
    v_mov_b64 v[242:243], v[244:245]
    v_mov_b64 v[244:245], v[246:247]
    s_waitcnt lgkmcnt(11)
    v_mfma_f32_16x16x32_bf16 v[112:115], v[16:19], v[64:67], 0
    s_waitcnt lgkmcnt(10)
    v_mfma_f32_16x16x32_bf16 v[112:115], v[20:23], v[68:71], v[112:115]
    s_waitcnt lgkmcnt(9)
    v_mfma_f32_16x16x32_bf16 v[112:115], v[24:27], v[72:75], v[112:115]
    s_waitcnt lgkmcnt(8)
    v_mfma_f32_16x16x32_bf16 v[112:115], v[28:31], v[76:79], v[112:115]
    s_waitcnt lgkmcnt(7)
    v_mfma_f32_16x16x32_bf16 v[112:115], v[32:35], v[80:83], v[112:115]
    s_waitcnt lgkmcnt(6)
    v_mfma_f32_16x16x32_bf16 v[112:115], v[36:39], v[84:87], v[112:115]
    s_waitcnt lgkmcnt(5)
    v_mfma_f32_16x16x32_bf16 v[112:115], v[40:43], v[88:91], v[112:115]
    s_waitcnt lgkmcnt(4)
    v_mfma_f32_16x16x32_bf16 v[112:115], v[44:47], v[92:95], v[112:115]
    s_waitcnt lgkmcnt(3)
    v_mfma_f32_16x16x32_bf16 v[112:115], v[48:51], v[96:99], v[112:115]
    s_waitcnt lgkmcnt(2)
    v_mfma_f32_16x16x32_bf16 v[112:115], v[52:55], v[100:103], v[112:115]
    s_waitcnt lgkmcnt(1)
    v_mfma_f32_16x16x32_bf16 v[112:115], v[56:59], v[104:107], v[112:115]
    s_waitcnt lgkmcnt(0)
    v_mfma_f32_16x16x32_bf16 v[112:115], v[60:63], v[108:111], v[112:115]
    v_add_u32 v120, s30, v120
    v_add_u32 v121, s30, v121
    v_add_u32 v122, s30, v122
    v_add_u32 v123, s30, v123
    s_nop 3
    v_cvt_pk_bf16_f32 v246, v112, v113
    v_cvt_pk_bf16_f32 v247, v114, v115
    s_cmp_ge_i32 s31, 9
    s_cbranch_scc1 L_ws_n
L_ws_i:
    s_mov_b32 m0, s50
    s_mov_b32 s33, s32
    v_xor_b32 v8, 0, v4
    buffer_load_dwordx4 v8, s[12:15], s33 offen lds
    s_add_u32 m0, m0, 1024
    v_xor_b32 v8, 0, v5
    buffer_load_dwordx4 v8, s[12:15], s33 offen lds
    s_add_u32 m0, m0, 1024
    v_xor_b32 v8, 0, v6
    buffer_load_dwordx4 v8, s[12:15], s33 offen lds
    s_add_u32 m0, m0, 1024
    s_add_u32 s33, s33, 6144
    v_xor_b32 v8, 32, v4
    buffer_load_dwordx4 v8, s[12:15], s33 offen lds
    s_add_u32 m0, m0, 1024
    v_xor_b32 v8, 32, v5
    buffer_load_dwordx4 v8, s[12:15], s33 offen lds
    s_add_u32 m0, m0, 1024
    v_xor_b32 v8, 32, v6
    buffer_load_dwordx4 v8, s[12:15], s33 offen lds
    s_add_u32 m0, m0, 1024
    s_add_u32 s33, s33, 6144
    v_xor_b32 v8, 48, v4
    buffer_load_dwordx4 v8, s[12:15], s33 offen lds
    s_add_u32 m0, m0, 1024
    v_xor_b32 v8, 48, v5
    buffer_load_dwordx4 v8, s[12:15], s33 offen lds
    s_add_u32 m0, m0, 1024
    v_xor_b32 v8, 48, v6
    buffer_load_dwordx4 v8, s[12:15], s33 offen lds
    s_add_u32 m0, m0, 1024
    s_add_u32 s33, s33, 6144
    v_xor_b32 v8, 16, v4
    buffer_load_dwordx4 v8, s[12:15], s33 offen lds
    s_add_u32 m0, m0, 1024
    v_xor_b32 v8, 16, v5
    buffer_load_dwordx4 v8, s[12:15], s33 offen lds
    s_add_u32 m0, m0, 1024
    v_xor_b32 v8, 16, v6
    buffer_load_dwordx4 v8, s[12:15], s33 offen lds
    s_add_u32 m0, m0, 1024
    s_add_u32 s50, s50, 12288
    s_cmp_eq_u32 s50, s49
    s_cselect_b32 s50, s34, s50
    s_xor_b32 s51, s51, 1
    s_cselect_b32 s30, 4, 28
    s_mul_i32 s30, s30, 768
    s_add_u32 s32, s32, s30
L_ws_n:
    s_add_u32 s31, s31, 1
    s_cmp_lt_i32 s31, 0
    s_cbranch_scc1 L_ws_i
    s_cmp_lt_i32 s31, 12
    s_cbranch_scc1 L_ws
    s_barrier
    v_lshrrev_b32 v7, 3, v0
    v_mul_u32_u24 v7, 3072, v7
    v_bfe_u32 v10, v0, 4, 1
    s_and_b32 s30, s3, 1
    s_lshl_b32 s30, s30, 1
    v_or_b32 v10, s30, v10
    v_lshlrev_b32 v10, 1, v10
    v_and_b32 v11, 7, v0
    v_xor_b32 v10, v10, v11
    v_lshl_add_u32 v7, v10, 4, v7
    s_lshl_b32 s34, s5, 7
    s_mul_i32 s30, s3, 24576
    s_add_u32 s34, s34, s30
    s_lshl_b32 s30, s3, 10
    s_add_u32 m0, s30, 0
    s_mov_b32 s31, 12
L_sl_26:
    buffer_load_dwordx4 v7, s[52:55], s34 offen lds
    s_add_u32 s34, s34, 98304
    s_add_u32 m0, m0, 4096
    s_sub_u32 s31, s31, 1
    s_cmp_lg_u32 s31, 0
    s_cbranch_scc1 L_sl_26
    s_lshl_b32 s32, s5, 5
    s_mul_i32 s30, s3, 294912
    s_add_u32 s32, s32, s30
    s_mul_i32 s33, s3, 12288
    s_add_u32 s33, s33, 49152
    s_mov_b32 m0, s33
    s_mov_b32 s31, 12
L_w2_27:
    buffer_load_dwordx4 v126, s[96:99], s32 offen lds
    s_add_u32 m0, m0, 1024
    s_add_u32 s32, s32, 24576
    s_sub_u32 s31, s31, 1
    s_cmp_lg_u32 s31, 0
    s_cbranch_scc1 L_w2_27
    v_bfe_u32 v10, v0, 2, 2
    v_lshrrev_b32 v11, 4, v0
    v_lshlrev_b32 v13, 10, v11
    v_lshl_add_u32 v13, v10, 7, v13
    v_lshrrev_b32 v10, 1, v10
    v_and_b32 v11, 1, v11
    v_lshl_or_b32 v10, v11, 1, v10
    v_lshl_add_u32 v13, v10, 5, v13
    v_and_b32 v10, 3, v0
    v_lshl_add_u32 v13, v10, 3, v13
    v_add_u32 v6, s33, v124
    v_add_u32 v7, s33, v125
    s_mov_b32 s30, 0x3f803f80
    v_mov_b32 v124, s30
    v_mov_b32 v125, s30
    v_mov_b32 v126, s30
    v_mov_b32 v127, s30
    s_lshl_b32 s30, s3, 5
    v_xor_b32 v8, s30, v13
    s_mul_i32 s30, s3, 12288
    v_add_u32 v13, s30, v8
    s_waitcnt vmcnt(12)
    s_barrier
    ds_read_b64_tr_b16 v[16:17], v8 offset:0
    ds_read_b64_tr_b16 v[18:19], v8 offset:512
    ds_read_b64_tr_b16 v[20:21], v8 offset:4096
    ds_read_b64_tr_b16 v[22:23], v8 offset:4608
    ds_read_b64_tr_b16 v[24:25], v8 offset:8192
    ds_read_b64_tr_b16 v[26:27], v8 offset:8704
    ds_read_b64_tr_b16 v[28:29], v8 offset:12288
    ds_read_b64_tr_b16 v[30:31], v8 offset:12800
    ds_read_b64_tr_b16 v[32:33], v8 offset:16384
    ds_read_b64_tr_b16 v[34:35], v8 offset:16896
    ds_read_b64_tr_b16 v[36:37], v8 offset:20480
    ds_read_b64_tr_b16 v[38:39], v8 offset:20992
    s_waitcnt lgkmcnt(0)
    ds_read_b64_tr_b16 v[40:41], v8 offset:24576
    ds_read_b64_tr_b16 v[42:43], v8 offset:25088
    ds_read_b64_tr_b16 v[44:45], v8 offset:28672
    ds_read_b64_tr_b16 v[46:47], v8 offset:29184
    ds_read_b64_tr_b16 v[48:49], v8 offset:32768
    ds_read_b64_tr_b16 v[50:51], v8 offset:33280
    ds_read_b64_tr_b16 v[52:53], v8 offset:36864
    ds_read_b64_tr_b16 v[54:55], v8 offset:37376
    ds_read_b64_tr_b16 v[56:57], v8 offset:40960
    ds_read_b64_tr_b16 v[58:59], v8 offset:41472
    ds_read_b64_tr_b16 v[60:61], v8 offset:45056
    ds_read_b64_tr_b16 v[62:63], v8 offset:45568
    s_waitcnt lgkmcnt(0)
    v_mfma_f32_16x16x32_bf16 v[248:251], v[16:19], v[124:127], 0
    v_mfma_f32_16x16x32_bf16 v[248:251], v[20:23], v[124:127], v[248:251]
    v_mfma_f32_16x16x32_bf16 v[248:251], v[24:27], v[124:127], v[248:251]
    v_mfma_f32_16x16x32_bf16 v[248:251], v[28:31], v[124:127], v[248:251]
    v_mfma_f32_16x16x32_bf16 v[248:251], v[32:35], v[124:127], v[248:251]
    v_mfma_f32_16x16x32_bf16 v[248:251], v[36:39], v[124:127], v[248:251]
    v_mfma_f32_16x16x32_bf16 v[248:251], v[40:43], v[124:127], v[248:251]
    v_mfma_f32_16x16x32_bf16 v[248:251], v[44:47], v[124:127], v[248:251]
    v_mfma_f32_16x16x32_bf16 v[248:251], v[48:51], v[124:127], v[248:251]
    v_mfma_f32_16x16x32_bf16 v[248:251], v[52:55], v[124:127], v[248:251]
    v_mfma_f32_16x16x32_bf16 v[248:251], v[56:59], v[124:127], v[248:251]
    v_mfma_f32_16x16x32_bf16 v[248:251], v[60:63], v[124:127], v[248:251]
    v_xor_b32 v10, 0, v13
    ds_read_b64_tr_b16 v[128:129], v10 offset:0
    ds_read_b64_tr_b16 v[130:131], v10 offset:512
    ds_read_b64_tr_b16 v[132:133], v10 offset:4096
    ds_read_b64_tr_b16 v[134:135], v10 offset:4608
    ds_read_b64_tr_b16 v[136:137], v10 offset:8192
    ds_read_b64_tr_b16 v[138:139], v10 offset:8704
    v_xor_b32 v10, 32, v13
    ds_read_b64_tr_b16 v[140:141], v10 offset:0
    ds_read_b64_tr_b16 v[142:143], v10 offset:512
    ds_read_b64_tr_b16 v[144:145], v10 offset:4096
    ds_read_b64_tr_b16 v[146:147], v10 offset:4608
    ds_read_b64_tr_b16 v[148:149], v10 offset:8192
    ds_read_b64_tr_b16 v[150:151], v10 offset:8704
    s_waitcnt lgkmcnt(0)
    v_xor_b32 v10, 64, v13
    ds_read_b64_tr_b16 v[152:153], v10 offset:0
    ds_read_b64_tr_b16 v[154:155], v10 offset:512
    ds_read_b64_tr_b16 v[156:157], v10 offset:4096
    ds_read_b64_tr_b16 v[158:159], v10 offset:4608
    ds_read_b64_tr_b16 v[160:161], v10 offset:8192
    ds_read_b64_tr_b16 v[162:163], v10 offset:8704
    v_xor_b32 v10, 96, v13
    ds_read_b64_tr_b16 v[164:165], v10 offset:0
    ds_read_b64_tr_b16 v[166:167], v10 offset:512
    ds_read_b64_tr_b16 v[168:169], v10 offset:4096
    ds_read_b64_tr_b16 v[170:171], v10 offset:4608
    ds_read_b64_tr_b16 v[172:173], v10 offset:8192
    ds_read_b64_tr_b16 v[174:175], v10 offset:8704
    s_waitcnt lgkmcnt(0)
    s_waitcnt vmcnt(0)
    ds_read_b64_tr_b16 v[176:177], v6 offset:0
    ds_read_b64_tr_b16 v[178:179], v7 offset:0
    ds_read_b64_tr_b16 v[180:181], v6 offset:1024
    ds_read_b64_tr_b16 v[182:183], v7 offset:1024
    ds_read_b64_tr_b16 v[184:185], v6 offset:2048
    ds_read_b64_tr_b16 v[186:187], v7 offset:2048
    ds_read_b64_tr_b16 v[188:189], v6 offset:3072
    ds_read_b64_tr_b16 v[190:191], v7 offset:3072
    ds_read_b64_tr_b16 v[192:193], v6 offset:4096
    ds_read_b64_tr_b16 v[194:195], v7 offset:4096
    ds_read_b64_tr_b16 v[196:197], v6 offset:5120
    ds_read_b64_tr_b16 v[198:199], v7 offset:5120
    s_waitcnt lgkmcnt(0)
    ds_read_b64_tr_b16 v[200:201], v6 offset:6144
    ds_read_b64_tr_b16 v[202:203], v7 offset:6144
    ds_read_b64_tr_b16 v[204:205], v6 offset:7168
    ds_read_b64_tr_b16 v[206:207], v7 offset:7168
    ds_read_b64_tr_b16 v[208:209], v6 offset:8192
    ds_read_b64_tr_b16 v[210:211], v7 offset:8192
    ds_read_b64_tr_b16 v[212:213], v6 offset:9216
    ds_read_b64_tr_b16 v[214:215], v7 offset:9216
    ds_read_b64_tr_b16 v[216:217], v6 offset:10240
    ds_read_b64_tr_b16 v[218:219], v7 offset:10240
    ds_read_b64_tr_b16 v[220:221], v6 offset:11264
    ds_read_b64_tr_b16 v[222:223], v7 offset:11264
    s_waitcnt lgkmcnt(0)
    v_and_b32 v1, 1, v0
    v_lshlrev_b32 v1, 7, v1
    s_mov_b64 exec, 3
    buffer_load_dwordx2 v[10:11], v1, s[20:23], 0 offen offset:16 sc1
    s_mov_b64 exec, -1
    s_waitcnt vmcnt(0)
L_lw_28:
    v_and_b32 v10, v10, v11
    v_cmp_eq_u32 vcc, 0, v10
    s_and_b32 s30, vcc_lo, 3
    s_cbranch_scc1 L_lw_28_r
L_lw_28_d:
    s_barrier
    s_lshl_b32 s38, s35, 1
    s_mul_i32 s30, s3, 6144
    s_add_u32 s38, s38, s30
    s_add_u32 s38, s38, 98304
    s_add_u32 s39, s38, 4096
    s_lshl_b32 s40, s5, 9
    s_add_u32 s40, s40, s35
    s_add_u32 s40, s40, 147456
    s_mul_i32 s43, s3, 3072
    s_add_u32 s43, s43, s35
    s_add_u32 s43, s43, 147456
    s_lshl_b32 s49, s5, 2
    s_add_u32 s49, s49, s3
    s_lshl_b32 s49, s49, 9
    s_lshl_b32 s30, s35, 2
    s_add_u32 s49, s49, s30
    s_add_u32 s49, s49, 180224
    s_mul_i32 s24, s3, 12288
    s_add_u32 s24, s24, s30
    s_add_u32 s24, s24, 180224
    s_add_u32 s25, s24, 4096
    s_add_u32 s26, s24, 8192
    s_lshl_b32 s30, s3, 12
    v_add_u32 v8, s30, v12
    v_xor_b32 v33, 4096, v8
    v_xor_b32 v34, 8192, v8
    v_xor_b32 v35, 12288, v8
    v_lshrrev_b32 v11, 2, v2
    v_lshl_add_u32 v11, v11, 4, v2
    v_lshlrev_b32 v11, 4, v11
    v_and_b32 v10, 3, v0
    v_cmp_eq_u32 s[28:29], 1, v10
    v_cmp_eq_u32 s[32:33], 2, v10
    v_cmp_eq_u32 s[50:51], 3, v10
    s_cmp_eq_u32 s3, 0
    s_cselect_b32 s30, -1, 0
    v_and_b32 v252, s30, v252
    v_and_b32 v253, s30, v253
    v_lshlrev_b32 v120, 16, v252
    v_and_b32 v121, 0xffff0000, v252
    v_lshlrev_b32 v122, 16, v253
    v_and_b32 v123, 0xffff0000, v253
    v_mov_b32 v36, 0xbdd2d3e8
    v_mov_b32 v37, 0xc0135761
    s_lshl_b32 s60, s4, 7
    s_mov_b64 exec, 1
    buffer_load_dwordx4 v[4:7], off, s[20:23], s60 sc1
    s_mov_b64 exec, -1
    buffer_load_dwordx4 v[64:67], v12, s[16:19], s43 offen offset:0 sc1
    buffer_load_dwordx4 v[68:71], v12, s[16:19], s43 offen offset:1024 sc1
    buffer_load_dwordx4 v[72:75], v12, s[16:19], s43 offen offset:2048 sc1
    buffer_load_dwordx4 v[64:67], v12, s[16:19], s24 offen offset:0 sc1
    buffer_load_dwordx4 v[68:71], v12, s[16:19], s24 offen offset:1024 sc1
    buffer_load_dwordx4 v[72:75], v12, s[16:19], s24 offen offset:2048 sc1
    buffer_load_dwordx4 v[76:79], v12, s[16:19], s24 offen offset:3072 sc1
    buffer_load_dwordx4 v[80:83], v12, s[16:19], s25 offen offset:0 sc1
    buffer_load_dwordx4 v[84:87], v12, s[16:19], s25 offen offset:1024 sc1
    buffer_load_dwordx4 v[88:91], v12, s[16:19], s25 offen offset:2048 sc1
    buffer_load_dwordx4 v[92:95], v12, s[16:19], s25 offen offset:3072 sc1
    buffer_load_dwordx4 v[96:99], v12, s[16:19], s26 offen offset:0 sc1
    buffer_load_dwordx4 v[100:103], v12, s[16:19], s26 offen offset:1024 sc1
    buffer_load_dwordx4 v[104:107], v12, s[16:19], s26 offen offset:2048 sc1
    buffer_load_dwordx4 v[108:111], v12, s[16:19], s26 offen offset:3072 sc1
    buffer_load_dwordx4 v[64:67], v12, s[16:19], s38 offen offset:0 sc1
    buffer_load_dwordx4 v[68:71], v12, s[16:19], s38 offen offset:1024 sc1
    buffer_load_dwordx4 v[72:75], v12, s[16:19], s38 offen offset:2048 sc1
    buffer_load_dwordx4 v[76:79], v12, s[16:19], s38 offen offset:3072 sc1
    buffer_load_dwordx4 v[80:83], v12, s[16:19], s39 offen offset:0 sc1
    buffer_load_dwordx4 v[84:87], v12, s[16:19], s39 offen offset:1024 sc1
    s_waitcnt vmcnt(0)
    v_readfirstlane_b32 s56, v6
    v_readfirstlane_b32 s57, v7
    s_getreg_b32 s30, hwreg(HW_REG_XCC_ID, 0, 4)
    s_lshl_b32 s30, s30, 3
    s_lshr_b64 s[56:57], s[56:57], s30
    s_and_b32 s56, s56, 0xff
    s_cmp_eq_u32 s56, 24
    s_cselect_b32 s59, 1, 0
    s_cmp_lt_u32 s30, 64
    s_cselect_b32 s59, s59, 0
    s_mul_i32 s52, s4, 147456
    s_mul_i32 s30, s5, 6144
    s_add_u32 s52, s52, s30
    s_lshl_b32 s30, s3, 8
    s_add_u32 s52, s52, s30
    s_add_u32 s52, s52, 278528
    s_add_u32 s53, s52, 4096
    s_mul_i32 s54, s4, 768
    s_add_u32 s54, s54, 573440
    s_lshl_b32 s55, s5, 10
    s_add_u32 s55, s55, s30
    s_lshl_b32 s30, s35, 1
    s_add_u32 s55, s55, s30
    s_add_u32 s55, s55, 98304
    v_lshlrev_b32 v6, 2, v0
    v_lshrrev_b32 v7, 2, v0
    v_lshlrev_b32 v7, 3, v7
    v_lshlrev_b32 v4, 7, v0
    s_mov_b64 exec, 0
    s_cmp_eq_u32 s3, 0
    s_cbranch_scc1 Lv_0
    s_cmp_eq_u32 s3, 1
    s_cbranch_scc1 Lv_1
    s_cmp_eq_u32 s3, 2
    s_cbranch_scc1 Lv_2
    s_branch Lv_3
Lv_ret:
    s_mov_b64 exec, -1
Lv_0:
    s_cbranch_execz Lv_4
    s_mov_b64 exec, 63
L_lp_29:
    buffer_load_dword v5, v4, s[16:19], s54 offen sc1
    s_waitcnt vmcnt(0)
    v_cmp_ne_u32 vcc, -1, v5
    s_cbranch_vccnz L_lp_29_d
    s_sleep 4
    s_sub_u32 s61, s61, 1
    s_cmp_gt_i32 s61, 0
    s_cbranch_scc1 L_lp_29
L_lp_29_d:
    s_mov_b64 exec, -1
L_g_30:
    buffer_load_dwordx2 v[44:45], v7, s[16:19], s54 offen offset:0 sc1
    buffer_load_dwordx2 v[46:47], v7, s[16:19], s54 offen offset:128 sc1
    buffer_load_dwordx2 v[48:49], v7, s[16:19], s54 offen offset:256 sc1
    buffer_load_dwordx2 v[50:51], v7, s[16:19], s54 offen offset:384 sc1
    buffer_load_dwordx2 v[52:53], v7, s[16:19], s54 offen offset:512 sc1
    buffer_load_dwordx2 v[54:55], v7, s[16:19], s54 offen offset:640 sc1
    s_sub_u32 s61, s61, 1
    s_cmp_gt_i32 s61, 0
    s_cselect_b64 s[62:63], -1, 0
    s_waitcnt vmcnt(5)
    v_max_u32 v10, v44, v45
    s_waitcnt vmcnt(4)
    v_max3_u32 v10, v10, v46, v47
    s_waitcnt vmcnt(3)
    v_max3_u32 v10, v10, v48, v49
    s_waitcnt vmcnt(2)
    v_max3_u32 v10, v10, v50, v51
    s_waitcnt vmcnt(1)
    v_max3_u32 v10, v10, v52, v53
    s_waitcnt vmcnt(0)
    v_max3_u32 v10, v10, v54, v55
    v_cmp_eq_u32 vcc, -1, v10
    s_and_b64 vcc, vcc, s[62:63]
    s_cbranch_scc1 L_g_30
    buffer_load_dword v56, v6, s[16:19], s52 offen offset:0 sc1
    buffer_load_dword v57, v6, s[16:19], s52 offen offset:1024 sc1
    buffer_load_dword v58, v6, s[16:19], s52 offen offset:2048 sc1
    buffer_load_dword v59, v6, s[16:19], s52 offen offset:3072 sc1
    buffer_load_dword v60, v6, s[16:19], s53 offen offset:0 sc1
    buffer_load_dword v61, v6, s[16:19], s53 offen offset:1024 sc1
    v_max3_f32 v4, v44, v46, v48
    v_max3_f32 v4, v4, v50, v52
    v_max_f32 v4, v4, v54
    v_sub_f32 v44, v44, v4
    v_sub_f32 v46, v46, v4
    v_sub_f32 v48, v48, v4
    v_sub_f32 v50, v50, v4
    v_sub_f32 v52, v52, v4
    v_sub_f32 v54, v54, v4
    v_exp_f32 v44, v44
    v_exp_f32 v46, v46
    v_exp_f32 v48, v48
    v_exp_f32 v50, v50
    v_exp_f32 v52, v52
    v_exp_f32 v54, v54
    v_mul_f32 v5, v44, v45
    v_fmac_f32 v5, v46, v47
    v_fmac_f32 v5, v48, v49
    v_fmac_f32 v5, v50, v51
    v_fmac_f32 v5, v52, v53
    v_fmac_f32 v5, v54, v55
    v_rcp_f32 v5, v5
    s_nop 0
    v_mul_f32 v44, v44, v5
    v_mul_f32 v46, v46, v5
    v_mul_f32 v48, v48, v5
    v_mul_f32 v50, v50, v5
    v_mul_f32 v52, v52, v5
    v_mul_f32 v54, v54, v5
    s_branch L_gx_31_c
L_gx_31:
    buffer_load_dword v56, v6, s[16:19], s52 offen offset:0 sc1
    buffer_load_dword v57, v6, s[16:19], s52 offen offset:1024 sc1
    buffer_load_dword v58, v6, s[16:19], s52 offen offset:2048 sc1
    buffer_load_dword v59, v6, s[16:19], s52 offen offset:3072 sc1
    buffer_load_dword v60, v6, s[16:19], s53 offen offset:0 sc1
    buffer_load_dword v61, v6, s[16:19], s53 offen offset:1024 sc1
L_gx_31_c:
    s_sub_u32 s61, s61, 1
    s_cmp_gt_i32 s61, 0
    s_cselect_b64 s[62:63], -1, 0
    s_waitcnt vmcnt(0)
    v_max3_u32 v10, v56, v57, v58
    v_max3_u32 v10, v10, v59, v60
    v_max_u32 v10, v10, v61
    v_cmp_eq_u32 vcc, -1, v10
    s_and_b64 vcc, vcc, s[62:63]
    s_cbranch_scc1 L_gx_31
    v_lshlrev_b32 v16, 16, v56
    v_and_b32 v17, 0xffff0000, v56
    v_pk_mul_f32 v[18:19], v[16:17], v[44:45] op_sel_hi:[1,0]
    v_lshlrev_b32 v16, 16, v57
    v_and_b32 v17, 0xffff0000, v57
    v_pk_fma_f32 v[18:19], v[16:17], v[46:47], v[18:19] op_sel_hi:[1,0,1]
    v_lshlrev_b32 v16, 16, v58
    v_and_b32 v17, 0xffff0000, v58
    v_pk_fma_f32 v[18:19], v[16:17], v[48:49], v[18:19] op_sel_hi:[1,0,1]
    v_lshlrev_b32 v16, 16, v59
    v_and_b32 v17, 0xffff0000, v59
    v_pk_fma_f32 v[18:19], v[16:17], v[50:51], v[18:19] op_sel_hi:[1,0,1]
    v_lshlrev_b32 v16, 16, v60
    v_and_b32 v17, 0xffff0000, v60
Lv_1:
    s_cbranch_execz Lv_ret
    v_pk_fma_f32 v[18:19], v[16:17], v[52:53], v[18:19] op_sel_hi:[1,0,1]
    v_lshlrev_b32 v16, 16, v61
    v_and_b32 v17, 0xffff0000, v61
    v_pk_fma_f32 v[18:19], v[16:17], v[54:55], v[18:19] op_sel_hi:[1,0,1]
    v_cvt_pk_bf16_f32 v18, v18, v19
    v_min_u32 v18, -2, v18
    s_cmp_lg_u32 s59, 0
    s_cbranch_scc0 L_hs_32
    buffer_store_dword v18, v6, s[16:19], s55 offen
L_hs_32_b:
L_g_33:
    buffer_load_dwordx4 v[64:67], v12, s[16:19], s38 offen offset:0 sc1
    buffer_load_dwordx4 v[68:71], v12, s[16:19], s38 offen offset:1024 sc1
    buffer_load_dwordx4 v[72:75], v12, s[16:19], s38 offen offset:2048 sc1
    buffer_load_dwordx4 v[76:79], v12, s[16:19], s38 offen offset:3072 sc1
    buffer_load_dwordx4 v[80:83], v12, s[16:19], s39 offen offset:0 sc1
    buffer_load_dwordx4 v[84:87], v12, s[16:19], s39 offen offset:1024 sc1
    s_sub_u32 s61, s61, 1
    s_cmp_gt_i32 s61, 0
    s_cselect_b64 s[62:63], -1, 0
    s_waitcnt vmcnt(5)
    v_mfma_f32_16x16x32_bf16 v[112:115], v[224:227], v[64:67], v[120:123]
    v_max_u32 v10, v64, v65
    v_max3_u32 v10, v10, v66, v67
    s_waitcnt vmcnt(4)
    v_mfma_f32_16x16x32_bf16 v[112:115], v[228:231], v[68:71], v[112:115]
    v_max3_u32 v10, v10, v68, v69
    v_max3_u32 v10, v10, v70, v71
    s_waitcnt vmcnt(3)
    v_mfma_f32_16x16x32_bf16 v[112:115], v[232:235], v[72:75], v[112:115]
    v_max3_u32 v10, v10, v72, v73
    v_max3_u32 v10, v10, v74, v75
    s_waitcnt vmcnt(2)
    v_mfma_f32_16x16x32_bf16 v[112:115], v[236:239], v[76:79], v[112:115]
    v_max3_u32 v10, v10, v76, v77
    v_max3_u32 v10, v10, v78, v79
    s_waitcnt vmcnt(1)
    v_mfma_f32_16x16x32_bf16 v[112:115], v[240:243], v[80:83], v[112:115]
    v_max3_u32 v10, v10, v80, v81
    v_max3_u32 v10, v10, v82, v83
    s_waitcnt vmcnt(0)
    v_mfma_f32_16x16x32_bf16 v[112:115], v[244:247], v[84:87], v[112:115]
    v_max3_u32 v10, v10, v84, v85
    v_max3_u32 v10, v10, v86, v87
    v_cmp_eq_u32 vcc, -1, v10
    s_and_b64 vcc, vcc, s[62:63]
    s_cbranch_scc1 L_g_33
    s_nop 0
    s_nop 1
    ds_write_b128 v9, v[112:115]
    s_waitcnt lgkmcnt(0)
    s_barrier
    s_cmp_lg_u32 s3, 0
    s_cbranch_scc1 L_t3_34
    ds_read_b128 v[20:23], v12 offset:1024
    ds_read_b128 v[24:27], v12 offset:2048
    ds_read_b128 v[28:31], v12 offset:3072
    s_waitcnt lgkmcnt(2)
    v_pk_add_f32 v[112:113], v[112:113], v[20:21]
    v_pk_add_f32 v[114:115], v[114:115], v[22:23]
    s_waitcnt lgkmcnt(1)
    v_pk_add_f32 v[112:113], v[112:113], v[24:25]
    v_pk_add_f32 v[114:115], v[114:115], v[26:27]
    s_waitcnt lgkmcnt(0)
    v_pk_add_f32 v[112:113], v[112:113], v[28:29]
    v_pk_add_f32 v[114:115], v[114:115], v[30:31]
    v_cvt_pk_bf16_f32 v116, v112, v113
    v_cvt_pk_bf16_f32 v117, v114, v115
    v_min_u32 v116, -2, v116
    v_min_u32 v117, -2, v117
    v_mov_b64 v[4:5], v[116:117]
    v_permlane16_swap_b32 v116, v118
    v_permlane16_swap_b32 v117, v119
    s_mov_b32 exec_lo, 0xffff
    s_mov_b32 exec_hi, 0xffff
    s_cmp_lg_u32 s59, 0
    s_cbranch_scc0 L_hs_35
    buffer_store_dwordx4 v[116:119], v14, s[16:19], s40 offen
L_hs_35_b:
    s_mov_b64 exec, -1
    v_lshlrev_b32 v120, 16, v4
    v_and_b32 v121, 0xffff0000, v4
    v_lshlrev_b32 v122, 16, v5
    v_and_b32 v123, 0xffff0000, v5
L_t3_34:
L_g_36:
    buffer_load_dwordx4 v[64:67], v12, s[16:19], s43 offen offset:0 sc1
    buffer_load_dwordx4 v[68:71], v12, s[16:19], s43 offen offset:1024 sc1
    buffer_load_dwordx4 v[72:75], v12, s[16:19], s43 offen offset:2048 sc1
    s_sub_u32 s61, s61, 1
    s_cmp_gt_i32 s61, 0
    s_cselect_b64 s[62:63], -1, 0
    s_waitcnt vmcnt(2)
    v_mfma_f32_16x16x32_bf16 v[88:91], v[64:67], v[64:67], 0
    v_mfma_f32_16x16x32_bf16 v[84:87], v[124:127], v[64:67], 0
    v_mfma_f32_16x16x32_bf16 v[100:103], v[140:143], v[64:67], 0
    v_mfma_f32_16x16x32_bf16 v[104:107], v[152:155], v[64:67], 0
    v_mfma_f32_16x16x32_bf16 v[108:111], v[164:167], v[64:67], 0
    v_mfma_f32_16x16x32_bf16 v[96:99], v[128:131], v[64:67], 0
    v_max_u32 v10, v64, v65
    v_max3_u32 v10, v10, v66, v67
    s_waitcnt vmcnt(1)
    v_mfma_f32_16x16x32_bf16 v[88:91], v[68:71], v[68:71], v[88:91]
    v_mfma_f32_16x16x32_bf16 v[84:87], v[124:127], v[68:71], v[84:87]
    v_mfma_f32_16x16x32_bf16 v[100:103], v[144:147], v[68:71], v[100:103]
Lv_2:
    s_cbranch_execz Lv_ret
    v_mfma_f32_16x16x32_bf16 v[104:107], v[156:159], v[68:71], v[104:107]
    v_mfma_f32_16x16x32_bf16 v[108:111], v[168:171], v[68:71], v[108:111]
    v_mfma_f32_16x16x32_bf16 v[96:99], v[132:135], v[68:71], v[96:99]
    v_max3_u32 v10, v10, v68, v69
    v_max3_u32 v10, v10, v70, v71
    s_waitcnt vmcnt(0)
    v_mfma_f32_16x16x32_bf16 v[88:91], v[72:75], v[72:75], v[88:91]
    v_mfma_f32_16x16x32_bf16 v[84:87], v[124:127], v[72:75], v[84:87]
    v_mfma_f32_16x16x32_bf16 v[100:103], v[148:151], v[72:75], v[100:103]
    v_mfma_f32_16x16x32_bf16 v[104:107], v[160:163], v[72:75], v[104:107]
    v_mfma_f32_16x16x32_bf16 v[108:111], v[172:175], v[72:75], v[108:111]
    v_mfma_f32_16x16x32_bf16 v[96:99], v[136:139], v[72:75], v[96:99]
    v_max3_u32 v10, v10, v72, v73
    v_max3_u32 v10, v10, v74, v75
    v_cmp_eq_u32 vcc, -1, v10
    s_and_b64 vcc, vcc, s[62:63]
    s_cbranch_scc1 L_g_36
    v_cndmask_b32 v85, v88, v89, s[28:29]
    v_cndmask_b32 v85, v85, v90, s[32:33]
    v_cndmask_b32 v85, v85, v91, s[50:51]
    ds_write_b128 v33, v[100:103] offset:5120
    ds_write_b128 v34, v[104:107] offset:6144
    ds_write_b128 v35, v[108:111] offset:7168
    ds_write_b64 v9, v[84:85] offset:20480
    s_waitcnt lgkmcnt(0)
    s_barrier
    ds_read_b64 v[16:17], v11 offset:20480
    ds_read_b64 v[18:19], v11 offset:21504
    ds_read_b64 v[20:21], v11 offset:22528
    ds_read_b64 v[22:23], v11 offset:23552
    ds_read_b128 v[100:103], v8 offset:5120
    ds_read_b128 v[104:107], v8 offset:6144
    ds_read_b128 v[108:111], v8 offset:7168
    s_waitcnt lgkmcnt(3)
    v_pk_add_f32 v[16:17], v[16:17], v[18:19]
    v_pk_add_f32 v[20:21], v[20:21], v[22:23]
    v_pk_add_f32 v[16:17], v[16:17], v[20:21]
    v_mul_f32 v16, 0x3b2aaaab, v16
    v_mul_f32 v17, 0x3b2aaaab, v17
    v_fma_f32 v17, -v16, v16, v17
    v_max_f32 v17, 0, v17
    v_add_f32 v17, 0x3727c5ac, v17
    v_rsq_f32 v17, v17
    s_waitcnt lgkmcnt(1)
    v_pk_fma_f32 v[96:97], v[248:249], v[16:17], v[96:97] op_sel_hi:[1,0,1] neg_lo:[0,1,0] neg_hi:[0,1,0]
    v_pk_fma_f32 v[98:99], v[250:251], v[16:17], v[98:99] op_sel_hi:[1,0,1] neg_lo:[0,1,0] neg_hi:[0,1,0]
    v_pk_add_f32 v[100:101], v[100:101], v[104:105]
    v_pk_add_f32 v[102:103], v[102:103], v[106:107]
    v_pk_add_f32 v[96:97], v[96:97], v[100:101]
    v_pk_add_f32 v[98:99], v[98:99], v[102:103]
    s_waitcnt lgkmcnt(0)
    v_pk_add_f32 v[96:97], v[96:97], v[108:109]
    v_pk_add_f32 v[98:99], v[98:99], v[110:111]
    v_pk_mul_f32 v[96:97], v[96:97], v[16:17] op_sel:[0,1] op_sel_hi:[1,1]
    v_pk_mul_f32 v[98:99], v[98:99], v[16:17] op_sel:[0,1] op_sel_hi:[1,1]
    v_pk_mul_f32 v[100:101], v[96:97], v[96:97]
    v_pk_mul_f32 v[102:103], v[98:99], v[98:99]
    v_pk_fma_f32 v[100:101], v[100:101], v[36:37], v[36:37] op_sel:[0,0,1] op_sel_hi:[1,0,1]
    v_pk_fma_f32 v[102:103], v[102:103], v[36:37], v[36:37] op_sel:[0,0,1] op_sel_hi:[1,0,1]
    v_pk_mul_f32 v[100:101], v[100:101], v[96:97]
    v_pk_mul_f32 v[102:103], v[102:103], v[98:99]
    v_exp_f32 v100, v100
    v_exp_f32 v101, v101
    v_exp_f32 v102, v102
    v_exp_f32 v103, v103
    v_pk_add_f32 v[100:101], v[100:101], 1.0 op_sel_hi:[1,0]
    v_pk_add_f32 v[102:103], v[102:103], 1.0 op_sel_hi:[1,0]
    v_rcp_f32 v100, v100
    v_rcp_f32 v101, v101
    v_rcp_f32 v102, v102
    v_rcp_f32 v103, v103
    v_pk_mul_f32 v[96:97], v[96:97], v[100:101]
    v_pk_mul_f32 v[98:99], v[98:99], v[102:103]
    v_cvt_pk_bf16_f32 v116, v96, v97
    v_cvt_pk_bf16_f32 v117, v98, v99
    v_min_u32 v116, -2, v116
    v_min_u32 v117, -2, v117
    s_nop 0
    v_permlane16_swap_b32 v116, v118
    v_permlane16_swap_b32 v117, v119
    s_mov_b32 exec_lo, 0xffff
    s_mov_b32 exec_hi, 0xffff
    s_cmp_lg_u32 s59, 0
    s_cbranch_scc0 L_hs_37
    buffer_store_dwordx4 v[116:119], v14, s[16:19], s49 offen
L_hs_37_b:
    s_mov_b64 exec, -1
L_g_38:
    buffer_load_dwordx4 v[64:67], v12, s[16:19], s24 offen offset:0 sc1
    buffer_load_dwordx4 v[68:71], v12, s[16:19], s24 offen offset:1024 sc1
    buffer_load_dwordx4 v[72:75], v12, s[16:19], s24 offen offset:2048 sc1
    buffer_load_dwordx4 v[76:79], v12, s[16:19], s24 offen offset:3072 sc1
    buffer_load_dwordx4 v[80:83], v12, s[16:19], s25 offen offset:0 sc1
    buffer_load_dwordx4 v[84:87], v12, s[16:19], s25 offen offset:1024 sc1
    buffer_load_dwordx4 v[88:91], v12, s[16:19], s25 offen offset:2048 sc1
    buffer_load_dwordx4 v[92:95], v12, s[16:19], s25 offen offset:3072 sc1
    buffer_load_dwordx4 v[96:99], v12, s[16:19], s26 offen offset:0 sc1
    buffer_load_dwordx4 v[100:103], v12, s[16:19], s26 offen offset:1024 sc1
    buffer_load_dwordx4 v[104:107], v12, s[16:19], s26 offen offset:2048 sc1
    buffer_load_dwordx4 v[108:111], v12, s[16:19], s26 offen offset:3072 sc1
    s_sub_u32 s61, s61, 1
    s_cmp_gt_i32 s61, 0
Lv_3:
    s_cbranch_execz Lv_ret
    s_cselect_b64 s[62:63], -1, 0
    s_waitcnt vmcnt(11)
    v_mfma_f32_16x16x32_bf16 v[112:115], v[176:179], v[64:67], v[120:123]
    v_max_u32 v10, v64, v65
    v_max3_u32 v10, v10, v66, v67
    s_waitcnt vmcnt(10)
    v_mfma_f32_16x16x32_bf16 v[112:115], v[180:183], v[68:71], v[112:115]
    v_max3_u32 v10, v10, v68, v69
    v_max3_u32 v10, v10, v70, v71
    s_waitcnt vmcnt(9)
    v_mfma_f32_16x16x32_bf16 v[112:115], v[184:187], v[72:75], v[112:115]
    v_max3_u32 v10, v10, v72, v73
    v_max3_u32 v10, v10, v74, v75
    s_waitcnt vmcnt(8)
    v_mfma_f32_16x16x32_bf16 v[112:115], v[188:191], v[76:79], v[112:115]
    v_max3_u32 v10, v10, v76, v77
    v_max3_u32 v10, v10, v78, v79
    s_waitcnt vmcnt(7)
    v_mfma_f32_16x16x32_bf16 v[112:115], v[192:195], v[80:83], v[112:115]
    v_max3_u32 v10, v10, v80, v81
    v_max3_u32 v10, v10, v82, v83
    s_waitcnt vmcnt(6)
    v_mfma_f32_16x16x32_bf16 v[112:115], v[196:199], v[84:87], v[112:115]
    v_max3_u32 v10, v10, v84, v85
    v_max3_u32 v10, v10, v86, v87
    s_waitcnt vmcnt(5)
    v_mfma_f32_16x16x32_bf16 v[112:115], v[200:203], v[88:91], v[112:115]
    v_max3_u32 v10, v10, v88, v89
    v_max3_u32 v10, v10, v90, v91
    s_waitcnt vmcnt(4)
    v_mfma_f32_16x16x32_bf16 v[112:115], v[204:207], v[92:95], v[112:115]
    v_max3_u32 v10, v10, v92, v93
    v_max3_u32 v10, v10, v94, v95
    s_waitcnt vmcnt(3)
    v_mfma_f32_16x16x32_bf16 v[112:115], v[208:211], v[96:99], v[112:115]
    v_max3_u32 v10, v10, v96, v97
    v_max3_u32 v10, v10, v98, v99
    s_waitcnt vmcnt(2)
    v_mfma_f32_16x16x32_bf16 v[112:115], v[212:215], v[100:103], v[112:115]
    v_max3_u32 v10, v10, v100, v101
    v_max3_u32 v10, v10, v102, v103
    s_waitcnt vmcnt(1)
    v_mfma_f32_16x16x32_bf16 v[112:115], v[216:219], v[104:107], v[112:115]
    v_max3_u32 v10, v10, v104, v105
    v_max3_u32 v10, v10, v106, v107
    s_waitcnt vmcnt(0)
    v_mfma_f32_16x16x32_bf16 v[112:115], v[220:223], v[108:111], v[112:115]
    v_max3_u32 v10, v10, v108, v109
    v_max3_u32 v10, v10, v110, v111
    v_cmp_eq_u32 vcc, -1, v10
    s_and_b64 vcc, vcc, s[62:63]
    s_cbranch_scc1 L_g_38
    s_nop 0
    s_nop 1
    ds_write_b128 v9, v[112:115]
    s_waitcnt lgkmcnt(0)
    s_barrier
    s_cmp_lg_u32 s3, 0
    s_cbranch_scc1 L_fin
    ds_read_b128 v[20:23], v12 offset:1024
    ds_read_b128 v[24:27], v12 offset:2048
    ds_read_b128 v[28:31], v12 offset:3072
    s_waitcnt lgkmcnt(2)
    v_pk_add_f32 v[112:113], v[112:113], v[20:21]
    v_pk_add_f32 v[114:115], v[114:115], v[22:23]
    s_waitcnt lgkmcnt(1)
    v_pk_add_f32 v[112:113], v[112:113], v[24:25]
    v_pk_add_f32 v[114:115], v[114:115], v[26:27]
    s_waitcnt lgkmcnt(0)
    v_pk_add_f32 v[112:113], v[112:113], v[28:29]
    v_pk_add_f32 v[114:115], v[114:115], v[30:31]
    v_cvt_pk_bf16_f32 v4, v112, v113
    v_cvt_pk_bf16_f32 v5, v114, v115
    buffer_store_dwordx2 v[4:5], v15, s[44:47], s48 offen
    s_branch L_fin
L_ew_18_r:
    s_sleep 2
    s_mov_b64 exec, 1
    buffer_load_dwordx4 v[132:135], off, s[20:23], s60 sc1
    s_mov_b64 exec, -1
    s_waitcnt vmcnt(0)
    s_sub_u32 s61, s61, 1
    s_cmp_gt_i32 s61, 0
    s_cbranch_scc1 L_ew_18
    s_branch L_ew_18_d
L_hs_19:
    buffer_store_dwordx4 v[116:119], v14, s[16:19], s38 offen sc1
    s_branch L_hs_19_b
L_hs_23:
    buffer_store_dwordx4 v[116:119], v14, s[16:19], s38 offen sc1
    s_branch L_hs_23_b
L_lw_28_r:
    s_sleep 8
    s_mov_b64 exec, 3
    buffer_load_dwordx2 v[10:11], v1, s[20:23], 0 offen offset:16 sc1
    s_mov_b64 exec, -1
    s_waitcnt vmcnt(0)
    s_sub_u32 s61, s61, 1
    s_cmp_gt_i32 s61, 0
    s_cbranch_scc1 L_lw_28
    s_branch L_lw_28_d
L_hs_32:
    buffer_store_dword v18, v6, s[16:19], s55 offen sc1
    s_branch L_hs_32_b
L_hs_35:
    buffer_store_dwordx4 v[116:119], v14, s[16:19], s40 offen sc1
Lv_4:
    s_cbranch_execz Lv_ret
    s_branch L_hs_35_b
L_hs_37:
    buffer_store_dwordx4 v[116:119], v14, s[16:19], s49 offen sc1
    s_branch L_hs_37_b
.fill (28672 - (. - standalone__detection_seg_detr_decoder__vision_kernel)) / 4, 4, 0xbf800000
    s_endpgm
    s_endpgm
.section .rodata,"a"
.p2align 6
.amdhsa_kernel standalone__detection_seg_detr_decoder__vision_kernel
  .amdhsa_next_free_vgpr 256
  .amdhsa_next_free_sgpr 100
  .amdhsa_accum_offset 256
  .amdhsa_group_segment_fixed_size 0
  .amdhsa_kernarg_size 104
  .amdhsa_user_sgpr_count 2
  .amdhsa_user_sgpr_kernarg_segment_ptr 1
  .amdhsa_system_sgpr_workgroup_id_x 1
.end_amdhsa_kernel
```
